```python
import torch

def _softmax(x, axis=-1):
    return torch.softmax(x, dim=axis)
def _gelu(x):
    return torch.nn.functional.gelu(x, approximate="tanh")
def _silu(x):
    return torch.nn.functional.silu(x)
def _sigmoid(x):
    return torch.sigmoid(x)
def _layernorm(x, axis=-1, eps=1e-5):
    m = x.mean(dim=axis, keepdim=True)
    v = x.var(dim=axis, keepdim=True, unbiased=False)
    return (x - m) / torch.sqrt(v + eps)
def _scatter_add(tgt, idx, src, axis=0):
    return tgt.clone().index_add_(axis, idx, src)
def _segment_sum(src, seg, n):
    out = torch.zeros((n,) + src.shape[1:], dtype=src.dtype)
    return out.index_add_(0, seg, src)
def _pad(x, pw):
    flat = tuple(v for pair in reversed(pw) for v in pair)
    return torch.nn.functional.pad(x, flat)

kernel_name = 'recurrent_scan__gqa_block_cached__swiglu_ffn__decode'

def setup_inputs():

    _w = (lambda a: (lambda t: t.to(torch.bfloat16) if t.is_floating_point() else t)(torch.as_tensor(a)))
    def _A_setup():
        B, Sq, D = 2, 1, 576
        Hq, Hkv, Sk, Dh = 32, 16, 32768, 128
        assert Hq % Hkv == 0, (Hq, Hkv)
        return {
            "x": _w((lambda *s: torch.randn(*s, dtype=torch.bfloat16) * 0.05)(B, Sq, D)),
            "k_cache": _w((lambda *s: torch.randn(*s, dtype=torch.bfloat16) * 1.6)(B, Hkv, Sk, Dh)),
            "v_cache": _w((lambda *s: torch.randn(*s, dtype=torch.bfloat16) * 0.2)(B, Hkv, Sk, Dh)),
            "wq": _w((lambda *s: torch.randn(*s, dtype=torch.bfloat16) * 1.6)(D, Hq * Dh) * (D ** -0.5)),
            "wo": _w((lambda *s: torch.randn(*s, dtype=torch.bfloat16) * 0.2)(Hq * Dh, D) * ((Hq * Dh) ** -0.5)),
        }
    _A_in = _A_setup()

    def _B_setup():
        B, S, D, F = 2, 1, 576, 4608
        return {
            "x": _w((lambda *s: torch.randn(*s, dtype=torch.bfloat16) * 0.05)(B, S, D)),
            "w_gate": _w((lambda *s: torch.randn(*s, dtype=torch.bfloat16) * 0.1)(D, F)),
            "w_up": _w((lambda *s: torch.randn(*s, dtype=torch.bfloat16) * 0.1)(D, F)),
            "w_down": _w((lambda *s: torch.randn(*s, dtype=torch.bfloat16) * 0.1)(F, D)),
        }
    _B_in = _B_setup()

    return {
        "A_x": _A_in["x"],
        "A_k_cache": _A_in["k_cache"],
        "A_v_cache": _A_in["v_cache"],
        "A_wq": _A_in["wq"],
        "A_wo": _A_in["wo"],
        "B_x": _B_in["x"],
        "B_w_gate": _B_in["w_gate"],
        "B_w_up": _B_in["w_up"],
        "B_w_down": _B_in["w_down"],
    }

def reference(A_x, A_k_cache, A_v_cache, A_wq, A_wo, B_x, B_w_gate, B_w_up, B_w_down):
    def _A_ref(x, k_cache, v_cache, wq, wo):
        B, Sq, D = x.shape
        Hq, Dh = 32, 128
        Hkv = k_cache.shape[1]
        rep = Hq // Hkv
        q = (lambda x, *d: x.permute(*d))((x @ wq).reshape(B, Sq, Hq, Dh), 0, 2, 1, 3)
        k = (lambda x, n, axis: torch.repeat_interleave(x, n, dim=axis))(k_cache, rep, axis=1)
        v = (lambda x, n, axis: torch.repeat_interleave(x, n, dim=axis))(v_cache, rep, axis=1)
        scores = torch.einsum("bhqd,bhkd->bhqk", q, k) * (Dh ** -0.5)
        p = _softmax(scores, axis=-1)
        o = torch.einsum("bhqk,bhkd->bhqd", p, v)
        return (lambda x, *d: x.permute(*d))(o, 0, 2, 1, 3).reshape(B, Sq, Hq * Dh) @ wo

    def _B_ref(x, w_gate, w_up, w_down):
        g = _silu(x @ w_gate)
        u = x @ w_up
        return (g * u) @ w_down

    x = A_x
    xn = _layernorm(x, axis=-1)
    s = _A_ref(xn, A_k_cache, A_v_cache, A_wq, A_wo)
    g = _silu(_B_ref(xn, B_w_gate, B_w_up, B_w_down))
    return x + s * g
```

```asm
; @launch grid=(256,1,1) block=(384,1,1) lds=16384
.amdgcn_target "amdgcn-amd-amdhsa--gfx950"
.text
.globl recurrent_scan__gqa_block_cached__swiglu_ffn__decode_kernel
.p2align 8
.type recurrent_scan__gqa_block_cached__swiglu_ffn__decode_kernel,@function
recurrent_scan__gqa_block_cached__swiglu_ffn__decode_kernel:
    s_cmp_ge_u32 s2, 256
    s_cbranch_scc1 L_end
    s_load_dwordx16 s[8:23], s[0:1], 0
    s_load_dwordx8 s[24:31], s[0:1], 64
    v_lshrrev_b32 v1, 6, v0
    v_and_b32 v0, 63, v0
    s_lshr_b32 s4, s2, 3
    v_readfirstlane_b32 s3, v1
    s_and_b32 s5, s2, 7
    s_lshr_b32 s6, s4, 4
    s_and_b32 s7, s4, 15
    s_cmp_ge_u32 s3, 2
    s_cbranch_scc1 L_st
    s_cmp_eq_u32 s3, 1
    s_cbranch_scc1 L_hf
    s_setprio 3
    v_lshrrev_b32 v18, 4, v0
    v_and_b32 v19, 15, v0
    v_and_b32 v20, 7, v0
    v_bfe_u32 v21, v0, 3, 1
    s_mul_i32 s40, s5, 589824
    s_lshl_b32 s41, s7, 1
    s_add_u32 s41, s41, s6
    s_lshl_b32 s41, s41, 8
    s_add_u32 s40, s40, s41
    v_mul_u32_u24 v56, 147456, v18
    v_lshl_add_u32 v56, v19, 4, v56
    v_add_u32 v56, s40, v56
    v_lshl_or_b32 v22, v18, 3, v20
    v_mul_u32_u24 v22, 36, v22
    v_mul_u32_u24 v23, 1152, v21
    v_add_u32 v22, v22, v23
    s_mov_b32 s34, 2304
    s_mov_b32 s35, 0x20000
    s_mov_b32 s38, 4718592
    s_mov_b32 s39, 0x20000
    s_mov_b32 s46, 4194304
    s_mov_b32 s47, 0x20000
    s_mul_i32 s42, s4, 4352
    s_add_u32 s42, s42, 2359296
    s_waitcnt lgkmcnt(0)
    s_mov_b64 s[32:33], s[8:9]
    s_mov_b64 s[36:37], s[14:15]
    s_mov_b64 s[44:45], s[30:31]
    s_cmp_lg_u32 s5, 0
    s_cbranch_scc1 L_noinit
    s_mov_b64 exec, 1
    buffer_store_dword v0, off, s[44:47], s42 sc1
    s_mov_b64 exec, -1
L_noinit:
    buffer_load_dwordx4 v[8:11], v22, s[32:35], 0 offen
    buffer_load_dwordx4 v[12:15], v22, s[32:35], 0 offen offset:16
    buffer_load_dword v16, v22, s[32:35], 0 offen offset:32
    buffer_load_dwordx4 v[64:67], v56, s[36:39], 0 offen nt
    s_mov_b32 s40, 8192
    buffer_load_dwordx4 v[68:71], v56, s[36:39], s40 offen nt
    s_mov_b32 s40, 16384
    buffer_load_dwordx4 v[72:75], v56, s[36:39], s40 offen nt
    s_mov_b32 s40, 24576
    buffer_load_dwordx4 v[76:79], v56, s[36:39], s40 offen nt
    s_mov_b32 s40, 32768
    buffer_load_dwordx4 v[80:83], v56, s[36:39], s40 offen nt
    s_mov_b32 s40, 40960
    buffer_load_dwordx4 v[84:87], v56, s[36:39], s40 offen nt
    s_mov_b32 s40, 49152
    buffer_load_dwordx4 v[88:91], v56, s[36:39], s40 offen nt
    s_mov_b32 s40, 57344
    buffer_load_dwordx4 v[92:95], v56, s[36:39], s40 offen nt
    s_mov_b32 s40, 65536
    buffer_load_dwordx4 v[96:99], v56, s[36:39], s40 offen nt
    s_mov_b32 s40, 73728
    buffer_load_dwordx4 v[100:103], v56, s[36:39], s40 offen nt
    s_mov_b32 s40, 81920
    buffer_load_dwordx4 v[104:107], v56, s[36:39], s40 offen nt
    s_mov_b32 s40, 90112
    buffer_load_dwordx4 v[108:111], v56, s[36:39], s40 offen nt
    s_mov_b32 s40, 98304
    buffer_load_dwordx4 v[112:115], v56, s[36:39], s40 offen nt
    s_mov_b32 s40, 106496
    buffer_load_dwordx4 v[116:119], v56, s[36:39], s40 offen nt
    s_mov_b32 s40, 114688
    buffer_load_dwordx4 v[120:123], v56, s[36:39], s40 offen nt
    s_mov_b32 s40, 122880
    buffer_load_dwordx4 v[124:127], v56, s[36:39], s40 offen nt
    s_mov_b32 s40, 131072
    buffer_load_dwordx4 v[128:131], v56, s[36:39], s40 offen nt
    s_mov_b32 s40, 139264
    buffer_load_dwordx4 v[132:135], v56, s[36:39], s40 offen nt
    s_barrier
    s_load_dword s92, s[30:31], 786432
    s_add_u32 s48, s30, s42
    s_addc_u32 s49, s31, 0
    v_and_b32 v24, 1, v0
    v_lshlrev_b32 v24, 4, v24
    v_mov_b32 v25, 0xffff
    v_lshlrev_b32 v24, v24, v25
    v_bfe_u32 v25, v0, 1, 2
    v_cmp_eq_u32 vcc, 0, v25
    s_nop 1
    v_cndmask_b32 v4, 0, v24, vcc
    v_cmp_eq_u32 vcc, 1, v25
    s_nop 1
    v_cndmask_b32 v5, 0, v24, vcc
    v_cmp_eq_u32 vcc, 2, v25
    s_nop 1
    v_cndmask_b32 v6, 0, v24, vcc
    v_cmp_eq_u32 vcc, 3, v25
    s_nop 1
    v_cndmask_b32 v7, 0, v24, vcc
    s_lshl_b32 s40, s7, 14
    s_lshl_b32 s41, s6, 12
    s_add_u32 s40, s40, s41
    s_lshl_b32 s41, s5, 9
    s_add_u32 s40, s40, s41
    v_lshl_add_u32 v57, v18, 3, v20
    v_lshlrev_b32 v57, 4, v57
    v_lshl_add_u32 v57, v21, 13, v57
    v_add_u32 v57, s40, v57
    s_mul_i32 s40, s5, 144
    v_mul_u32_u24 v24, 36, v18
    v_add3_u32 v24, v24, v23, s40
    s_waitcnt vmcnt(18)
    v_lshlrev_b32 v32, 16, v8
    v_and_b32 v33, 0xffff0000, v8
    v_lshlrev_b32 v34, 16, v9
    v_and_b32 v35, 0xffff0000, v9
    v_lshlrev_b32 v36, 16, v10
    v_and_b32 v37, 0xffff0000, v10
    v_lshlrev_b32 v38, 16, v11
    v_and_b32 v39, 0xffff0000, v11
    v_lshlrev_b32 v40, 16, v12
    v_and_b32 v41, 0xffff0000, v12
    v_lshlrev_b32 v42, 16, v13
    v_and_b32 v43, 0xffff0000, v13
    v_lshlrev_b32 v44, 16, v14
    v_and_b32 v45, 0xffff0000, v14
    v_lshlrev_b32 v46, 16, v15
    v_and_b32 v47, 0xffff0000, v15
    v_lshlrev_b32 v48, 16, v16
    v_and_b32 v49, 0xffff0000, v16
    v_add_f32 v26, v32, v33
    v_add_f32 v27, v34, v35
    v_add_f32 v26, v26, v36
    v_add_f32 v27, v27, v37
    v_add_f32 v26, v26, v38
    v_add_f32 v27, v27, v39
    v_add_f32 v26, v26, v40
    v_add_f32 v27, v27, v41
    v_add_f32 v26, v26, v42
    v_add_f32 v27, v27, v43
    v_add_f32 v26, v26, v44
    v_add_f32 v27, v27, v45
    v_add_f32 v26, v26, v46
    v_add_f32 v27, v27, v47
    v_add_f32 v26, v26, v48
    v_add_f32 v27, v27, v49
    v_add_f32 v26, v26, v27
    s_nop 1
    v_add_f32_dpp v26, v26, v26 quad_perm:[1,0,3,2] row_mask:0xf bank_mask:0xf
    s_nop 1
    v_add_f32_dpp v26, v26, v26 quad_perm:[2,3,0,1] row_mask:0xf bank_mask:0xf
    s_nop 1
    v_add_f32_dpp v26, v26, v26 row_half_mirror row_mask:0xf bank_mask:0xf
    v_mov_b32 v27, v26
    s_nop 1
    v_permlane16_swap_b32 v26, v27
    s_nop 0
    v_add_f32 v26, v26, v27
    v_mov_b32 v27, v26
    s_nop 1
    v_permlane32_swap_b32 v26, v27
    s_nop 0
    v_add_f32 v26, v26, v27
    v_mul_f32 v26, 0x3ae38e39, v26
    v_sub_f32 v27, v32, v26
    v_mul_f32 v28, v27, v27
    v_sub_f32 v27, v33, v26
    v_mul_f32 v29, v27, v27
    v_sub_f32 v27, v34, v26
    v_fmac_f32 v28, v27, v27
    v_sub_f32 v27, v35, v26
    v_fmac_f32 v29, v27, v27
    v_sub_f32 v27, v36, v26
    v_fmac_f32 v28, v27, v27
    v_sub_f32 v27, v37, v26
    v_fmac_f32 v29, v27, v27
    v_sub_f32 v27, v38, v26
    v_fmac_f32 v28, v27, v27
    v_sub_f32 v27, v39, v26
    v_fmac_f32 v29, v27, v27
    v_sub_f32 v27, v40, v26
    v_fmac_f32 v28, v27, v27
    v_sub_f32 v27, v41, v26
    v_fmac_f32 v29, v27, v27
    v_sub_f32 v27, v42, v26
    v_fmac_f32 v28, v27, v27
    v_sub_f32 v27, v43, v26
    v_fmac_f32 v29, v27, v27
    v_sub_f32 v27, v44, v26
    v_fmac_f32 v28, v27, v27
    v_sub_f32 v27, v45, v26
    v_fmac_f32 v29, v27, v27
    v_sub_f32 v27, v46, v26
    v_fmac_f32 v28, v27, v27
    v_sub_f32 v27, v47, v26
    v_fmac_f32 v29, v27, v27
    v_sub_f32 v27, v48, v26
    v_fmac_f32 v28, v27, v27
    v_sub_f32 v27, v49, v26
    v_fmac_f32 v29, v27, v27
    v_add_f32 v28, v28, v29
    s_nop 1
    v_add_f32_dpp v28, v28, v28 quad_perm:[1,0,3,2] row_mask:0xf bank_mask:0xf
    s_nop 1
    v_add_f32_dpp v28, v28, v28 quad_perm:[2,3,0,1] row_mask:0xf bank_mask:0xf
    s_nop 1
    v_add_f32_dpp v28, v28, v28 row_half_mirror row_mask:0xf bank_mask:0xf
    v_mov_b32 v27, v28
    s_nop 1
    v_permlane16_swap_b32 v28, v27
    s_nop 0
    v_add_f32 v28, v28, v27
    v_mov_b32 v27, v28
    s_nop 1
    v_permlane32_swap_b32 v28, v27
    s_nop 0
    v_add_f32 v28, v28, v27
    v_mul_f32 v28, 0x3ae38e39, v28
    v_cvt_pk_bf16_f32 v28, v28, v28
    v_and_b32 v28, 0xffff0000, v28
    v_add_f32 v28, 0x3727c5ac, v28
    v_cvt_pk_bf16_f32 v28, v28, v28
    v_and_b32 v28, 0xffff0000, v28
    v_sqrt_f32 v28, v28
    s_nop 0
    v_cvt_pk_bf16_f32 v28, v28, v28
    v_and_b32 v28, 0xffff0000, v28
    v_rcp_f32 v28, v28
    v_cvt_pk_bf16_f32 v26, v26, v26
    v_and_b32 v26, 0xffff0000, v26
    v_sub_f32 v32, v32, v26
    v_sub_f32 v33, v33, v26
    v_cvt_pk_bf16_f32 v27, v32, v33
    v_lshlrev_b32 v32, 16, v27
    v_and_b32 v33, 0xffff0000, v27
    v_mul_f32 v32, v32, v28
    v_mul_f32 v33, v33, v28
    v_cvt_pk_bf16_f32 v8, v32, v33
    v_sub_f32 v34, v34, v26
    v_sub_f32 v35, v35, v26
    v_cvt_pk_bf16_f32 v27, v34, v35
    v_lshlrev_b32 v34, 16, v27
    v_and_b32 v35, 0xffff0000, v27
    v_mul_f32 v34, v34, v28
    v_mul_f32 v35, v35, v28
    v_cvt_pk_bf16_f32 v9, v34, v35
    v_sub_f32 v36, v36, v26
    v_sub_f32 v37, v37, v26
    v_cvt_pk_bf16_f32 v27, v36, v37
    v_lshlrev_b32 v36, 16, v27
    v_and_b32 v37, 0xffff0000, v27
    v_mul_f32 v36, v36, v28
    v_mul_f32 v37, v37, v28
    v_cvt_pk_bf16_f32 v10, v36, v37
    v_sub_f32 v38, v38, v26
    v_sub_f32 v39, v39, v26
    v_cvt_pk_bf16_f32 v27, v38, v39
    v_lshlrev_b32 v38, 16, v27
    v_and_b32 v39, 0xffff0000, v27
    v_mul_f32 v38, v38, v28
    v_mul_f32 v39, v39, v28
    v_cvt_pk_bf16_f32 v11, v38, v39
    v_sub_f32 v40, v40, v26
    v_sub_f32 v41, v41, v26
    v_cvt_pk_bf16_f32 v27, v40, v41
    v_lshlrev_b32 v40, 16, v27
    v_and_b32 v41, 0xffff0000, v27
    v_mul_f32 v40, v40, v28
    v_mul_f32 v41, v41, v28
    v_cvt_pk_bf16_f32 v12, v40, v41
    v_sub_f32 v42, v42, v26
    v_sub_f32 v43, v43, v26
    v_cvt_pk_bf16_f32 v27, v42, v43
    v_lshlrev_b32 v42, 16, v27
    v_and_b32 v43, 0xffff0000, v27
    v_mul_f32 v42, v42, v28
    v_mul_f32 v43, v43, v28
    v_cvt_pk_bf16_f32 v13, v42, v43
    v_sub_f32 v44, v44, v26
    v_sub_f32 v45, v45, v26
    v_cvt_pk_bf16_f32 v27, v44, v45
    v_lshlrev_b32 v44, 16, v27
    v_and_b32 v45, 0xffff0000, v27
    v_mul_f32 v44, v44, v28
    v_mul_f32 v45, v45, v28
    v_cvt_pk_bf16_f32 v14, v44, v45
    v_sub_f32 v46, v46, v26
    v_sub_f32 v47, v47, v26
    v_cvt_pk_bf16_f32 v27, v46, v47
    v_lshlrev_b32 v46, 16, v27
    v_and_b32 v47, 0xffff0000, v27
    v_mul_f32 v46, v46, v28
    v_mul_f32 v47, v47, v28
    v_cvt_pk_bf16_f32 v15, v46, v47
    v_sub_f32 v48, v48, v26
    v_sub_f32 v49, v49, v26
    v_cvt_pk_bf16_f32 v27, v48, v49
    v_lshlrev_b32 v48, 16, v27
    v_and_b32 v49, 0xffff0000, v27
    v_mul_f32 v48, v48, v28
    v_mul_f32 v49, v49, v28
    v_cvt_pk_bf16_f32 v16, v48, v49
    ds_write_b32 v22, v8 offset:1024
    ds_write_b32 v22, v9 offset:1028
    ds_write_b32 v22, v10 offset:1032
    ds_write_b32 v22, v11 offset:1036
    ds_write_b32 v22, v12 offset:1040
    ds_write_b32 v22, v13 offset:1044
    ds_write_b32 v22, v14 offset:1048
    ds_write_b32 v22, v15 offset:1052
    ds_write_b32 v22, v16 offset:1056
    s_mov_b32 s40, 0x01000100
    s_mov_b32 s41, 0x03020302
    s_waitcnt lgkmcnt(0)
    ds_read_b32 v8, v24 offset:1024
    ds_read_b32 v9, v24 offset:1028
    ds_read_b32 v10, v24 offset:1032
    ds_read_b32 v11, v24 offset:1036
    ds_read_b32 v12, v24 offset:1040
    ds_read_b32 v13, v24 offset:1044
    ds_read_b32 v14, v24 offset:1048
    ds_read_b32 v15, v24 offset:1052
    ds_read_b32 v16, v24 offset:1056
    s_add_u32 s93, s92, 2654435769
    s_bfe_u32 s94, s93, 524288
    s_bfe_u32 s95, s93, 524296
    s_bfe_u32 s96, s93, 524304
    s_bfe_u32 s97, s93, 524312
    v_mov_b32 v227, 0xffffff00
    s_waitcnt lgkmcnt(8)
    v_perm_b32 v26, v8, v8, s40
    v_and_b32 v136, v26, v4
    v_and_b32 v137, v26, v5
    v_and_b32 v138, v26, v6
    v_and_b32 v139, v26, v7
    v_perm_b32 v26, v8, v8, s41
    v_and_b32 v140, v26, v4
    v_and_b32 v141, v26, v5
    v_and_b32 v142, v26, v6
    v_and_b32 v143, v26, v7
    s_waitcnt lgkmcnt(7)
    v_perm_b32 v26, v9, v9, s40
    v_and_b32 v144, v26, v4
    v_and_b32 v145, v26, v5
    v_and_b32 v146, v26, v6
    v_and_b32 v147, v26, v7
    v_perm_b32 v26, v9, v9, s41
    v_and_b32 v148, v26, v4
    v_and_b32 v149, v26, v5
    v_and_b32 v150, v26, v6
    v_and_b32 v151, v26, v7
    s_waitcnt lgkmcnt(6)
    v_perm_b32 v26, v10, v10, s40
    v_and_b32 v152, v26, v4
    v_and_b32 v153, v26, v5
    v_and_b32 v154, v26, v6
    v_and_b32 v155, v26, v7
    v_perm_b32 v26, v10, v10, s41
    v_and_b32 v156, v26, v4
    v_and_b32 v157, v26, v5
    v_and_b32 v158, v26, v6
    v_and_b32 v159, v26, v7
    s_waitcnt lgkmcnt(5)
    v_perm_b32 v26, v11, v11, s40
    v_and_b32 v160, v26, v4
    v_and_b32 v161, v26, v5
    v_and_b32 v162, v26, v6
    v_and_b32 v163, v26, v7
    v_perm_b32 v26, v11, v11, s41
    v_and_b32 v164, v26, v4
    v_and_b32 v165, v26, v5
    v_and_b32 v166, v26, v6
    v_and_b32 v167, v26, v7
    s_waitcnt lgkmcnt(4)
    v_perm_b32 v26, v12, v12, s40
    v_and_b32 v168, v26, v4
    v_and_b32 v169, v26, v5
    v_and_b32 v170, v26, v6
    v_and_b32 v171, v26, v7
    v_perm_b32 v26, v12, v12, s41
    v_and_b32 v172, v26, v4
    v_and_b32 v173, v26, v5
    v_and_b32 v174, v26, v6
    v_and_b32 v175, v26, v7
    s_waitcnt lgkmcnt(3)
    v_perm_b32 v26, v13, v13, s40
    v_and_b32 v176, v26, v4
    v_and_b32 v177, v26, v5
    v_and_b32 v178, v26, v6
    v_and_b32 v179, v26, v7
    v_perm_b32 v26, v13, v13, s41
    v_and_b32 v180, v26, v4
    v_and_b32 v181, v26, v5
    v_and_b32 v182, v26, v6
    v_and_b32 v183, v26, v7
    s_waitcnt lgkmcnt(2)
    v_perm_b32 v26, v14, v14, s40
    v_and_b32 v184, v26, v4
    v_and_b32 v185, v26, v5
    v_and_b32 v186, v26, v6
    v_and_b32 v187, v26, v7
    v_perm_b32 v26, v14, v14, s41
    v_and_b32 v188, v26, v4
    v_and_b32 v189, v26, v5
    v_and_b32 v190, v26, v6
    v_and_b32 v191, v26, v7
    s_waitcnt lgkmcnt(1)
    v_perm_b32 v26, v15, v15, s40
    v_and_b32 v192, v26, v4
    v_and_b32 v193, v26, v5
    v_and_b32 v194, v26, v6
    v_and_b32 v195, v26, v7
    v_perm_b32 v26, v15, v15, s41
    v_and_b32 v196, v26, v4
    v_and_b32 v197, v26, v5
    v_and_b32 v198, v26, v6
    v_and_b32 v199, v26, v7
    s_waitcnt lgkmcnt(0)
    v_perm_b32 v26, v16, v16, s40
    v_and_b32 v200, v26, v4
    v_and_b32 v201, v26, v5
    v_and_b32 v202, v26, v6
    v_and_b32 v203, v26, v7
    v_perm_b32 v26, v16, v16, s41
    v_and_b32 v204, v26, v4
    v_and_b32 v205, v26, v5
    v_and_b32 v206, v26, v6
    v_and_b32 v207, v26, v7
    s_waitcnt vmcnt(17)
    v_mfma_f32_16x16x32_bf16 v[52:55], v[64:67], v[136:139], 0
    s_waitcnt vmcnt(16)
    v_mfma_f32_16x16x32_bf16 v[52:55], v[68:71], v[140:143], v[52:55]
    s_waitcnt vmcnt(15)
    v_mfma_f32_16x16x32_bf16 v[52:55], v[72:75], v[144:147], v[52:55]
    s_waitcnt vmcnt(14)
    v_mfma_f32_16x16x32_bf16 v[52:55], v[76:79], v[148:151], v[52:55]
    s_waitcnt vmcnt(13)
    v_mfma_f32_16x16x32_bf16 v[52:55], v[80:83], v[152:155], v[52:55]
    s_waitcnt vmcnt(12)
    v_mfma_f32_16x16x32_bf16 v[52:55], v[84:87], v[156:159], v[52:55]
    s_waitcnt vmcnt(11)
    v_mfma_f32_16x16x32_bf16 v[52:55], v[88:91], v[160:163], v[52:55]
    s_waitcnt vmcnt(10)
    v_mfma_f32_16x16x32_bf16 v[52:55], v[92:95], v[164:167], v[52:55]
    s_waitcnt vmcnt(9)
    v_mfma_f32_16x16x32_bf16 v[52:55], v[96:99], v[168:171], v[52:55]
    s_waitcnt vmcnt(8)
    v_mfma_f32_16x16x32_bf16 v[52:55], v[100:103], v[172:175], v[52:55]
    s_waitcnt vmcnt(7)
    v_mfma_f32_16x16x32_bf16 v[52:55], v[104:107], v[176:179], v[52:55]
    s_waitcnt vmcnt(6)
    v_mfma_f32_16x16x32_bf16 v[52:55], v[108:111], v[180:183], v[52:55]
    s_waitcnt vmcnt(5)
    v_mfma_f32_16x16x32_bf16 v[52:55], v[112:115], v[184:187], v[52:55]
    s_waitcnt vmcnt(4)
    v_mfma_f32_16x16x32_bf16 v[52:55], v[116:119], v[188:191], v[52:55]
    s_waitcnt vmcnt(3)
    v_mfma_f32_16x16x32_bf16 v[52:55], v[120:123], v[192:195], v[52:55]
    s_waitcnt vmcnt(2)
    v_mfma_f32_16x16x32_bf16 v[52:55], v[124:127], v[196:199], v[52:55]
    s_waitcnt vmcnt(1)
    v_mfma_f32_16x16x32_bf16 v[52:55], v[128:131], v[200:203], v[52:55]
    s_waitcnt vmcnt(0)
    v_mfma_f32_16x16x32_bf16 v[52:55], v[132:135], v[204:207], v[52:55]
    s_lshl_b32 s40, s7, 14
    s_lshl_b32 s41, s6, 13
    s_add_u32 s40, s40, s41
    v_and_b32 v26, 31, v0
    v_lshlrev_b32 v26, 4, v26
    v_lshrrev_b32 v27, 5, v0
    v_lshl_add_u32 v26, v27, 12, v26
    s_nop 0
    v_and_or_b32 v52, v52, v227, s94
    v_and_or_b32 v53, v53, v227, s95
    v_and_or_b32 v54, v54, v227, s96
    v_and_or_b32 v55, v55, v227, s97
    buffer_store_dwordx4 v[52:55], v57, s[44:47], 0 offen sc1
    v_bfe_u32 v28, v0, 3, 2
    v_lshl_add_u32 v28, v28, 5, v20
    v_lshlrev_b32 v28, 1, v28
    v_lshl_add_u32 v28, v27, 8, v28
    v_mov_b32 v32, 8
    v_mov_b32 v33, s92
    v_mov_b32 v34, 0
    ds_write_b64 v34, v[32:33] offset:512
    v_mov_b32 v40, -1
    ds_write_b32 v34, v40 offset:524
    v_lshlrev_b32 v35, 4, v0
    v_mov_b32 v36, -1
    v_mov_b32 v37, -1
    v_mov_b32 v38, -1
    v_mov_b32 v39, -1
    ds_write_b128 v35, v[36:39] offset:15360
    s_mov_b32 s42, 4000000
L_qpoll:
    buffer_load_dwordx4 v[64:67], v26, s[44:47], s40 offen offset:0 sc1
    buffer_load_dwordx4 v[68:71], v26, s[44:47], s40 offen offset:512 sc1
    buffer_load_dwordx4 v[72:75], v26, s[44:47], s40 offen offset:1024 sc1
    buffer_load_dwordx4 v[76:79], v26, s[44:47], s40 offen offset:1536 sc1
    buffer_load_dwordx4 v[80:83], v26, s[44:47], s40 offen offset:2048 sc1
    buffer_load_dwordx4 v[84:87], v26, s[44:47], s40 offen offset:2560 sc1
    buffer_load_dwordx4 v[88:91], v26, s[44:47], s40 offen offset:3072 sc1
    buffer_load_dwordx4 v[92:95], v26, s[44:47], s40 offen offset:3584 sc1
    s_waitcnt vmcnt(7)
    v_xor_b32 v64, s94, v64
    v_xor_b32 v65, s95, v65
    v_xor_b32 v66, s96, v66
    v_xor_b32 v67, s97, v67
    v_or_b32 v29, v64, v65
    v_or3_b32 v29, v29, v66, v67
    s_waitcnt vmcnt(6)
    v_xor_b32 v68, s94, v68
    v_xor_b32 v69, s95, v69
    v_xor_b32 v70, s96, v70
    v_xor_b32 v71, s97, v71
    v_or3_b32 v29, v29, v68, v69
    v_or3_b32 v29, v29, v70, v71
    v_add_f32 v64, v64, v68
    v_add_f32 v65, v65, v69
    v_add_f32 v66, v66, v70
    v_add_f32 v67, v67, v71
    s_waitcnt vmcnt(5)
    v_xor_b32 v72, s94, v72
    v_xor_b32 v73, s95, v73
    v_xor_b32 v74, s96, v74
    v_xor_b32 v75, s97, v75
    v_or3_b32 v29, v29, v72, v73
    v_or3_b32 v29, v29, v74, v75
    v_add_f32 v64, v64, v72
    v_add_f32 v65, v65, v73
    v_add_f32 v66, v66, v74
    v_add_f32 v67, v67, v75
    s_waitcnt vmcnt(4)
    v_xor_b32 v76, s94, v76
    v_xor_b32 v77, s95, v77
    v_xor_b32 v78, s96, v78
    v_xor_b32 v79, s97, v79
    v_or3_b32 v29, v29, v76, v77
    v_or3_b32 v29, v29, v78, v79
    v_add_f32 v64, v64, v76
    v_add_f32 v65, v65, v77
    v_add_f32 v66, v66, v78
    v_add_f32 v67, v67, v79
    s_waitcnt vmcnt(3)
    v_xor_b32 v80, s94, v80
    v_xor_b32 v81, s95, v81
    v_xor_b32 v82, s96, v82
    v_xor_b32 v83, s97, v83
    v_or3_b32 v29, v29, v80, v81
    v_or3_b32 v29, v29, v82, v83
    v_add_f32 v64, v64, v80
    v_add_f32 v65, v65, v81
    v_add_f32 v66, v66, v82
    v_add_f32 v67, v67, v83
    s_waitcnt vmcnt(2)
    v_xor_b32 v84, s94, v84
    v_xor_b32 v85, s95, v85
    v_xor_b32 v86, s96, v86
    v_xor_b32 v87, s97, v87
    v_or3_b32 v29, v29, v84, v85
    v_or3_b32 v29, v29, v86, v87
    v_add_f32 v64, v64, v84
    v_add_f32 v65, v65, v85
    v_add_f32 v66, v66, v86
    v_add_f32 v67, v67, v87
    s_waitcnt vmcnt(1)
    v_xor_b32 v88, s94, v88
    v_xor_b32 v89, s95, v89
    v_xor_b32 v90, s96, v90
    v_xor_b32 v91, s97, v91
    v_or3_b32 v29, v29, v88, v89
    v_or3_b32 v29, v29, v90, v91
    v_add_f32 v64, v64, v88
    v_add_f32 v65, v65, v89
    v_add_f32 v66, v66, v90
    v_add_f32 v67, v67, v91
    s_waitcnt vmcnt(0)
    v_xor_b32 v92, s94, v92
    v_xor_b32 v93, s95, v93
    v_xor_b32 v94, s96, v94
    v_xor_b32 v95, s97, v95
    v_or3_b32 v29, v29, v92, v93
    v_or3_b32 v29, v29, v94, v95
    v_add_f32 v64, v64, v92
    v_add_f32 v65, v65, v93
    v_add_f32 v66, v66, v94
    v_add_f32 v67, v67, v95
    v_and_b32 v29, 0xff, v29
    v_cmp_ne_u32 vcc, 0, v29
    s_cbranch_vccz L_qready
    s_sub_u32 s42, s42, 1
    s_cmp_lg_u32 s42, 0
    s_cbranch_scc1 L_qpoll
L_qready:
    v_cvt_pk_bf16_f32 v64, v64, v65
    v_cvt_pk_bf16_f32 v66, v66, v67
    ds_write_b16 v28, v64 offset:0
    ds_write_b16_d16_hi v28, v64 offset:16
    ds_write_b16 v28, v66 offset:32
    ds_write_b16_d16_hi v28, v66 offset:48
    s_waitcnt lgkmcnt(0)
    s_barrier
    s_setprio 0
    s_mov_b32 s83, 4
    v_lshlrev_b32 v19, 4, v19
    s_mov_b32 s88, s16
    s_mov_b32 s89, s17
    s_mov_b32 s90, 4718592
    s_mov_b32 s91, 0x20000
    s_lshl_b32 s84, s7, 8
    s_lshl_b32 s85, s5, 5
    s_add_u32 s84, s84, s85
    s_mul_i32 s84, s84, 1152
    s_lshl_b32 s85, s83, 8
    s_add_u32 s84, s84, s85
    v_mul_u32_u24 v22, 9216, v18
    v_add3_u32 v22, v22, v19, s84
    s_cmp_eq_u32 s83, 4
    s_cselect_b32 s84, 0x08000000, 0
    s_cselect_b32 s87, 0, 0x00ff00ff
    s_mov_b32 s86, 0x00ff00ff
    v_and_b32 v23, 8, v0
    v_mul_lo_u32 v23, v23, s84
    v_add_u32 v22, v22, v23
    v_mov_b32 v236, v22
    v_add_u32 v237, 3456, v22
    v_add_u32 v238, 6912, v22
    buffer_load_dwordx4 v[192:195], v236, s[88:91], 0 offen offset:0 nt
    buffer_load_dwordx4 v[196:199], v236, s[88:91], 0 offen offset:1152 nt
    buffer_load_dwordx4 v[200:203], v236, s[88:91], 0 offen offset:2304 nt
    buffer_load_dwordx4 v[204:207], v237, s[88:91], 0 offen offset:0 nt
    buffer_load_dwordx4 v[208:211], v237, s[88:91], 0 offen offset:1152 nt
    buffer_load_dwordx4 v[212:215], v237, s[88:91], 0 offen offset:2304 nt
    buffer_load_dwordx4 v[216:219], v238, s[88:91], 0 offen offset:0 nt
    buffer_load_dwordx4 v[220:223], v238, s[88:91], 0 offen offset:1152 nt
    s_mul_i32 s84, s6, 294912
    s_lshl_b32 s85, s7, 3
    s_add_u32 s85, s85, s5
    s_lshl_b32 s85, s85, 6
    s_add_u32 s84, s84, s85
    s_lshl_b32 s85, s83, 16
    s_add_u32 s84, s84, s85
    s_add_u32 s84, s84, 851968
    v_lshlrev_b32 v226, 14, v18
    v_bfe_u32 v22, v0, 2, 1
    v_lshl_add_u32 v226, v22, 13, v226
    v_and_b32 v22, 3, v0
    v_lshl_add_u32 v226, v22, 4, v226
    v_add_u32 v226, s84, v226
    s_lshl_b32 s84, s4, 14
    s_lshr_b32 s85, s5, 2
    s_xor_b32 s85, s85, 0
    s_lshl_b32 s85, s85, 13
    s_add_u32 s84, s84, s85
    s_add_u32 s84, s84, 266240
    v_and_b32 v225, 0x38, v0
    v_lshl_add_u32 v225, v225, 4, s84
    s_and_b32 s85, s5, 3
    s_lshl_b32 s85, s85, 10
    s_add_u32 s84, s84, s85
    s_sub_u32 s84, s84, 4096
    v_lshl_add_u32 v224, v0, 4, s84
    s_mov_b32 s84, 0x3fb8aa3b
    v_xor_b32 v61, 0, v21
    v_lshlrev_b32 v61, 13, v61
    s_lshl_b32 s40, s4, 14
    s_add_u32 s40, s40, 262144
    v_add_u32 v61, s40, v61
    v_lshl_add_u32 v60, v18, 10, v61
    v_lshl_add_u32 v60, v20, 4, v60
    s_lshl_b32 s41, s5, 7
    v_add_u32 v60, s41, v60
    s_lshl_b32 s41, s5, 7
    s_add_u32 s41, s41, 4096
    v_add_u32 v61, s41, v61
    v_lshlrev_b32 v62, 4, v0
    v_lshlrev_b32 v63, 3, v0
    s_mov_b32 s46, 0
    s_mov_b32 s59, 1
    s_branch L_tail
L_real:
    s_mov_b32 s46, 4194304
    s_mov_b32 s59, 4000000
    s_mov_b64 exec, -1
    v_mov_b32 v1, 1
    ds_write_b32 v63, v1 offset:3584
    s_waitcnt vmcnt(0) lgkmcnt(0)
    s_setprio 3
L_pw0:
    s_sleep 16
    v_mov_b32 v1, 0
    ds_read_b32 v1, v1 offset:512
    s_waitcnt lgkmcnt(0)
    v_readfirstlane_b32 s42, v1
    s_cmp_lt_u32 s42, 160
    s_cbranch_scc1 L_pw0
    s_mov_b32 s41, 790528
    s_mov_b32 s40, 4000000
L_pw1:
    buffer_load_dwordx2 v[2:3], off, s[44:47], s41 sc1
    s_sub_u32 s40, s40, 1
    s_waitcnt vmcnt(0)
    v_cmp_ne_u32 vcc, s93, v3
    s_cbranch_vccz L_pw2
    s_sleep 16
    s_cmp_lg_u32 s40, 0
    s_cbranch_scc1 L_pw1
L_pw2:
    v_and_b32 v2, 1, v2
    v_lshlrev_b32 v2, 13, v2
    v_xor_b32 v60, v60, v2
    v_xor_b32 v61, v61, v2
    v_xor_b32 v224, v224, v2
    v_xor_b32 v225, v225, v2
    v_xor_b32 v226, v226, v2
    v_mov_b32 v1, 0
    ds_write_b32 v1, v2 offset:520
L_dlz:
    s_sleep 16
    v_mov_b32 v1, 0
    ds_read_b32 v1, v1 offset:512
    s_waitcnt lgkmcnt(0)
    v_readfirstlane_b32 s42, v1
    s_cmp_lt_u32 s42, 232
    s_cbranch_scc1 L_dlz
    s_mov_b32 s40, 238
    s_mov_b32 s41, 0
L_disp:
    v_mov_b32 v1, 0
    ds_read_b32 v1, v1 offset:512
    s_waitcnt lgkmcnt(0)
    v_readfirstlane_b32 s42, v1
    s_cmp_ge_u32 s42, s40
    s_cbranch_scc1 L_claim
    s_sleep 1
    s_branch L_disp
L_claim:
    s_mov_b32 s42, 1
    s_atomic_add s42, s[48:49], 0 glc
    v_mov_b32 v1, s41
    s_waitcnt lgkmcnt(0)
    s_cmp_ge_u32 s42, 32
    s_cbranch_scc1 L_dend
    v_mov_b32 v2, s42
    ds_write_b32 v1, v2 offset:15360
    s_add_u32 s40, s40, 4
    s_add_u32 s41, s41, 4
    s_branch L_disp
L_dend:
    v_lshl_add_u32 v1, v0, 2, s41
    v_mov_b32 v2, 0x7fffffff
    ds_write_b32 v1, v2 offset:15360
    s_add_u32 s40, s40, 13
    v_mov_b32 v1, 0
    v_mov_b32 v2, s40
    ds_write_b32 v1, v2 offset:524
    s_waitcnt lgkmcnt(0)
    s_barrier
L_tail:
    ds_read_b64 v[80:81], v63 offset:13312
    ds_read_b64 v[82:83], v63 offset:13824
    ds_read_b64 v[84:85], v63 offset:14336
    ds_read_b64 v[86:87], v63 offset:14848
    ds_read_b128 v[64:67], v62 offset:9216
    ds_read_b128 v[68:71], v62 offset:10240
    ds_read_b128 v[72:75], v62 offset:11264
    ds_read_b128 v[76:79], v62 offset:12288
    v_mov_b32 v53, s93
    v_mov_b32 v55, s93
    s_waitcnt lgkmcnt(4)
    v_max3_f32 v52, v80, v82, v84
    v_max_f32 v52, v52, v86
    v_sub_f32 v44, v80, v52
    v_sub_f32 v45, v82, v52
    v_sub_f32 v46, v84, v52
    v_sub_f32 v47, v86, v52
    v_mul_f32 v44, s84, v44
    v_mul_f32 v45, s84, v45
    v_mul_f32 v46, s84, v46
    v_mul_f32 v47, s84, v47
    v_exp_f32 v44, v44
    v_exp_f32 v45, v45
    v_exp_f32 v46, v46
    v_exp_f32 v47, v47
    s_waitcnt lgkmcnt(0)
    v_mul_f32 v48, v44, v64
    v_mul_f32 v49, v44, v65
    v_mul_f32 v50, v44, v66
    v_mul_f32 v51, v44, v67
    v_fmac_f32 v48, v45, v68
    v_fmac_f32 v49, v45, v69
    v_fmac_f32 v50, v45, v70
    v_fmac_f32 v51, v45, v71
    v_fmac_f32 v48, v46, v72
    v_fmac_f32 v49, v46, v73
    v_fmac_f32 v50, v46, v74
    v_fmac_f32 v51, v46, v75
    v_fmac_f32 v48, v47, v76
    v_fmac_f32 v49, v47, v77
    v_fmac_f32 v50, v47, v78
    v_fmac_f32 v51, v47, v79
    v_and_or_b32 v48, v48, v227, s94
    v_and_or_b32 v49, v49, v227, s95
    v_and_or_b32 v50, v50, v227, s96
    v_and_or_b32 v51, v51, v227, s97
    buffer_store_dwordx4 v[48:51], v60, s[44:47], 0 offen sc1
    v_mul_f32 v54, v44, v81
    v_fmac_f32 v54, v45, v83
    v_fmac_f32 v54, v46, v85
    v_fmac_f32 v54, v47, v87
    s_mov_b64 exec, 0x101
    buffer_store_dwordx4 v[52:55], v61, s[44:47], 0 offen sc1
    s_mov_b64 exec, -1
    s_mov_b32 s85, s59
L_opoll:
    buffer_load_dwordx4 v[228:231], v224, s[44:47], 0 offen sc1
    buffer_load_dwordx4 v[232:235], v225, s[44:47], 0 offen sc1
    s_sub_u32 s85, s85, 1
    s_waitcnt vmcnt(1)
    v_xor_b32 v228, s94, v228
    v_xor_b32 v229, s95, v229
    v_xor_b32 v230, s96, v230
    v_xor_b32 v231, s97, v231
    v_or_b32 v2, v228, v229
    v_or3_b32 v2, v2, v230, v231
    v_and_b32 v2, 0xff, v2
    s_waitcnt vmcnt(0)
    v_bitop3_b32 v2, v2, v233, s93 bitop3:0xf6
    v_bitop3_b32 v2, v2, v235, s93 bitop3:0xf6
    v_cmp_ne_u32 vcc, 0, v2
    s_cbranch_vccz L_oready
    s_cmp_lg_u32 s85, 0
    s_cbranch_scc1 L_opoll
L_oready:
    v_mov_b32 v1, v232
    s_nop 1
    v_max_f32_dpp v1, v1, v1 row_ror:8 row_mask:0xf bank_mask:0xf
    v_mov_b32 v2, v1
    s_nop 1
    v_permlane16_swap_b32 v1, v2
    s_nop 0
    v_max_f32 v1, v1, v2
    v_mov_b32 v2, v1
    s_nop 1
    v_permlane32_swap_b32 v1, v2
    s_nop 0
    v_max_f32 v1, v1, v2
    v_sub_f32 v1, v232, v1
    v_mul_f32 v1, s84, v1
    v_exp_f32 v1, v1
    s_nop 0
    v_mul_f32 v234, v1, v234
    v_mul_f32 v228, v1, v228
    v_mul_f32 v229, v1, v229
    v_mul_f32 v230, v1, v230
    v_mul_f32 v231, v1, v231
    v_add_f32_dpp v234, v234, v234 row_ror:8 row_mask:0xf bank_mask:0xf
    v_add_f32_dpp v228, v228, v228 row_ror:8 row_mask:0xf bank_mask:0xf
    v_add_f32_dpp v229, v229, v229 row_ror:8 row_mask:0xf bank_mask:0xf
    v_add_f32_dpp v230, v230, v230 row_ror:8 row_mask:0xf bank_mask:0xf
    v_add_f32_dpp v231, v231, v231 row_ror:8 row_mask:0xf bank_mask:0xf
    v_mov_b32 v2, v234
    s_nop 0
    v_permlane16_swap_b32 v228, v229
    v_permlane16_swap_b32 v230, v231
    v_permlane16_swap_b32 v234, v2
    v_add_f32 v228, v228, v229
    v_add_f32 v230, v230, v231
    v_add_f32 v234, v234, v2
    v_mov_b32 v2, v234
    s_nop 0
    v_permlane32_swap_b32 v228, v230
    v_permlane32_swap_b32 v234, v2
    v_add_f32 v228, v228, v230
    v_add_f32 v234, v234, v2
    v_rcp_f32 v2, v234
    s_nop 0
    v_mul_f32 v1, v228, v2
    v_cvt_pk_bf16_f32 v1, v1, v1
    ds_write_b32 v63, v1 offset:3584
    s_nop 0
L_tail3:
    v_and_b32_dpp v8, v1, v4 row_newbcast:0 row_mask:0xf bank_mask:0xf
    v_and_b32_dpp v9, v1, v5 row_newbcast:0 row_mask:0xf bank_mask:0xf
    v_and_b32_dpp v10, v1, v6 row_newbcast:0 row_mask:0xf bank_mask:0xf
    v_and_b32_dpp v11, v1, v7 row_newbcast:0 row_mask:0xf bank_mask:0xf
    v_and_b32_dpp v12, v1, v4 row_newbcast:1 row_mask:0xf bank_mask:0xf
    v_and_b32_dpp v13, v1, v5 row_newbcast:1 row_mask:0xf bank_mask:0xf
    v_and_b32_dpp v14, v1, v6 row_newbcast:1 row_mask:0xf bank_mask:0xf
    v_and_b32_dpp v15, v1, v7 row_newbcast:1 row_mask:0xf bank_mask:0xf
    v_mfma_f32_16x16x32_bf16 v[40:43], v[192:195], v[8:11], 0
    v_and_b32_dpp v16, v1, v4 row_newbcast:2 row_mask:0xf bank_mask:0xf
    v_and_b32_dpp v17, v1, v5 row_newbcast:2 row_mask:0xf bank_mask:0xf
    v_and_b32_dpp v18, v1, v6 row_newbcast:2 row_mask:0xf bank_mask:0xf
    v_and_b32_dpp v19, v1, v7 row_newbcast:2 row_mask:0xf bank_mask:0xf
    v_mfma_f32_16x16x32_bf16 v[40:43], v[196:199], v[12:15], v[40:43]
    v_and_b32_dpp v20, v1, v4 row_newbcast:3 row_mask:0xf bank_mask:0xf
    v_and_b32_dpp v21, v1, v5 row_newbcast:3 row_mask:0xf bank_mask:0xf
    v_and_b32_dpp v22, v1, v6 row_newbcast:3 row_mask:0xf bank_mask:0xf
    v_and_b32_dpp v23, v1, v7 row_newbcast:3 row_mask:0xf bank_mask:0xf
    v_mfma_f32_16x16x32_bf16 v[40:43], v[200:203], v[16:19], v[40:43]
    v_and_b32_dpp v24, v1, v4 row_newbcast:4 row_mask:0xf bank_mask:0xf
    v_and_b32_dpp v25, v1, v5 row_newbcast:4 row_mask:0xf bank_mask:0xf
    v_and_b32_dpp v26, v1, v6 row_newbcast:4 row_mask:0xf bank_mask:0xf
    v_and_b32_dpp v27, v1, v7 row_newbcast:4 row_mask:0xf bank_mask:0xf
    v_mfma_f32_16x16x32_bf16 v[40:43], v[204:207], v[20:23], v[40:43]
    v_and_b32_dpp v28, v1, v4 row_newbcast:5 row_mask:0xf bank_mask:0xf
    v_and_b32_dpp v29, v1, v5 row_newbcast:5 row_mask:0xf bank_mask:0xf
    v_and_b32_dpp v30, v1, v6 row_newbcast:5 row_mask:0xf bank_mask:0xf
    v_and_b32_dpp v31, v1, v7 row_newbcast:5 row_mask:0xf bank_mask:0xf
    v_mfma_f32_16x16x32_bf16 v[40:43], v[208:211], v[24:27], v[40:43]
    v_and_b32_dpp v32, v1, v4 row_newbcast:6 row_mask:0xf bank_mask:0xf
    v_and_b32_dpp v33, v1, v5 row_newbcast:6 row_mask:0xf bank_mask:0xf
    v_and_b32_dpp v34, v1, v6 row_newbcast:6 row_mask:0xf bank_mask:0xf
    v_and_b32_dpp v35, v1, v7 row_newbcast:6 row_mask:0xf bank_mask:0xf
    v_mfma_f32_16x16x32_bf16 v[40:43], v[212:215], v[28:31], v[40:43]
    v_and_b32_dpp v36, v1, v4 row_newbcast:7 row_mask:0xf bank_mask:0xf
    v_and_b32_dpp v37, v1, v5 row_newbcast:7 row_mask:0xf bank_mask:0xf
    v_and_b32_dpp v38, v1, v6 row_newbcast:7 row_mask:0xf bank_mask:0xf
    v_and_b32_dpp v39, v1, v7 row_newbcast:7 row_mask:0xf bank_mask:0xf
    v_mfma_f32_16x16x32_bf16 v[40:43], v[216:219], v[32:35], v[40:43]
    s_nop 0
    v_mfma_f32_16x16x32_bf16 v[40:43], v[220:223], v[36:39], v[40:43]
    s_nop 6
    s_mov_b64 exec, s[86:87]
    v_and_or_b32 v40, v40, v227, s94
    v_and_or_b32 v41, v41, v227, s95
    v_and_or_b32 v42, v42, v227, s96
    v_and_or_b32 v43, v43, v227, s97
    buffer_store_dwordx4 v[40:43], v226, s[44:47], 0 offen sc1
    s_cmp_eq_u32 s59, 1
    s_cbranch_scc1 L_real
    s_endpgm
L_st:
    v_and_b32 v1, 0x30, v0
    v_bfe_u32 v3, v0, 0, 1
    v_lshl_or_b32 v1, v3, 8, v1
    v_bfe_u32 v3, v0, 1, 1
    v_lshl_or_b32 v1, v3, 9, v1
    v_bfe_u32 v3, v0, 2, 1
    v_lshl_or_b32 v1, v3, 13, v1
    v_bfe_u32 v3, v0, 3, 1
    v_lshl_or_b32 v1, v3, 16, v1
    v_and_b32 v3, 15, v0
    v_lshlrev_b32 v2, 4, v3
    v_bfe_u32 v3, v0, 4, 1
    v_lshl_or_b32 v2, v3, 13, v2
    v_lshrrev_b32 v3, 5, v0
    v_lshl_or_b32 v2, v3, 16, v2
    s_sub_u32 s42, s3, 2
    s_lshl_b32 s40, s4, 23
    s_lshl_b32 s53, s5, 20
    s_bfe_u32 s54, s42, 65536
    s_lshl_b32 s54, s54, 11
    s_add_u32 s41, s53, s54
    s_bfe_u32 s54, s42, 65537
    s_lshl_b32 s54, s54, 14
    s_add_u32 s41, s41, s54
    s_mov_b32 s55, s41
    s_mov_b32 s34, 0x800000
    s_mov_b32 s35, 0x20000
    s_mov_b32 s38, 0x800000
    s_mov_b32 s39, 0x20000
    s_waitcnt lgkmcnt(0)
    s_add_u32 s32, s10, s40
    s_addc_u32 s33, s11, 0
    s_add_u32 s36, s12, s40
    s_addc_u32 s37, s13, 0
    v_lshrrev_b32 v34, 4, v0
    v_and_b32 v35, 15, v0
    v_lshlrev_b32 v35, 4, v35
    s_mov_b32 s88, s16
    s_mov_b32 s89, s17
    s_mov_b32 s90, 4718592
    s_mov_b32 s91, 0x20000
    s_lshl_b32 s84, s7, 8
    s_lshl_b32 s85, s5, 5
    s_add_u32 s84, s84, s85
    s_mul_i32 s84, s84, 1152
    s_lshl_b32 s85, s42, 8
    s_add_u32 s84, s84, s85
    v_mul_u32_u24 v36, 9216, v34
    v_add3_u32 v36, v36, v35, s84
    s_cmp_eq_u32 s42, 4
    s_cselect_b32 s84, 0x08000000, 0
    s_cselect_b32 s87, 0, 0x00ff00ff
    s_mov_b32 s86, 0x00ff00ff
    v_and_b32 v37, 8, v0
    v_mul_lo_u32 v37, v37, s84
    v_add_u32 v36, v36, v37
    v_mov_b32 v236, v36
    v_add_u32 v237, 3456, v36
    v_add_u32 v238, 6912, v36
    s_barrier
    buffer_load_dwordx4 v[192:195], v236, s[88:91], 0 offen offset:0 nt
    buffer_load_dwordx4 v[196:199], v236, s[88:91], 0 offen offset:1152 nt
    buffer_load_dwordx4 v[200:203], v236, s[88:91], 0 offen offset:2304 nt
    buffer_load_dwordx4 v[204:207], v237, s[88:91], 0 offen offset:0 nt
    buffer_load_dwordx4 v[208:211], v237, s[88:91], 0 offen offset:1152 nt
    buffer_load_dwordx4 v[212:215], v237, s[88:91], 0 offen offset:2304 nt
    buffer_load_dwordx4 v[216:219], v238, s[88:91], 0 offen offset:0 nt
    buffer_load_dwordx4 v[220:223], v238, s[88:91], 0 offen offset:1152 nt
    buffer_load_dwordx4 v[64:67], v1, s[32:35], s41 offen offset:0 nt
    buffer_load_dwordx4 v[68:71], v1, s[32:35], s41 offen offset:64 nt
    buffer_load_dwordx4 v[72:75], v1, s[32:35], s41 offen offset:128 nt
    buffer_load_dwordx4 v[76:79], v1, s[32:35], s41 offen offset:192 nt
    buffer_load_dwordx4 v[80:83], v2, s[36:39], s41 offen offset:0 nt
    buffer_load_dwordx4 v[84:87], v2, s[36:39], s41 offen offset:256 nt
    buffer_load_dwordx4 v[88:91], v2, s[36:39], s41 offen offset:512 nt
    buffer_load_dwordx4 v[92:95], v2, s[36:39], s41 offen offset:768 nt
    s_add_u32 s41, s55, 1024
    buffer_load_dwordx4 v[96:99], v1, s[32:35], s41 offen offset:0 nt
    buffer_load_dwordx4 v[100:103], v1, s[32:35], s41 offen offset:64 nt
    buffer_load_dwordx4 v[104:107], v1, s[32:35], s41 offen offset:128 nt
    buffer_load_dwordx4 v[108:111], v1, s[32:35], s41 offen offset:192 nt
    buffer_load_dwordx4 v[112:115], v2, s[36:39], s41 offen offset:0 nt
    buffer_load_dwordx4 v[116:119], v2, s[36:39], s41 offen offset:256 nt
    buffer_load_dwordx4 v[120:123], v2, s[36:39], s41 offen offset:512 nt
    buffer_load_dwordx4 v[124:127], v2, s[36:39], s41 offen offset:768 nt
    s_mov_b32 s49, 0
    s_mul_i32 s84, s6, 294912
    s_lshl_b32 s85, s7, 3
    s_add_u32 s85, s85, s5
    s_lshl_b32 s85, s85, 6
    s_add_u32 s84, s84, s85
    s_lshl_b32 s85, s42, 16
    s_add_u32 s84, s84, s85
    s_add_u32 s84, s84, 851968
    v_lshlrev_b32 v226, 14, v34
    v_bfe_u32 v36, v0, 2, 1
    v_lshl_add_u32 v226, v36, 13, v226
    v_and_b32 v36, 3, v0
    v_lshl_add_u32 v226, v36, 4, v226
    v_add_u32 v226, s84, v226
    s_lshl_b32 s84, s4, 14
    s_lshr_b32 s85, s5, 2
    s_xor_b32 s85, s85, 0
    s_lshl_b32 s85, s85, 13
    s_add_u32 s84, s84, s85
    s_add_u32 s84, s84, 266240
    v_and_b32 v225, 0x38, v0
    v_lshl_add_u32 v225, v225, 4, s84
    s_and_b32 s85, s5, 3
    s_lshl_b32 s85, s85, 10
    s_add_u32 s84, s84, s85
    s_sub_u32 s84, s84, 4096
    v_lshl_add_u32 v224, v0, 4, s84
    s_mov_b32 s84, 0x3fb8aa3b
    s_mov_b32 s44, s30
    s_mov_b32 s45, s31
    s_mov_b32 s46, 4194304
    s_mov_b32 s47, 0x20000
    s_mov_b32 s59, 4000000
    v_and_b32 v34, 1, v0
    v_lshlrev_b32 v34, 4, v34
    v_mov_b32 v35, 0xffff
    v_lshlrev_b32 v34, v34, v35
    v_bfe_u32 v35, v0, 1, 2
    v_cmp_eq_u32 vcc, 0, v35
    s_nop 1
    v_cndmask_b32 v4, 0, v34, vcc
    v_cmp_eq_u32 vcc, 1, v35
    s_nop 1
    v_cndmask_b32 v5, 0, v34, vcc
    v_cmp_eq_u32 vcc, 2, v35
    s_nop 1
    v_cndmask_b32 v6, 0, v34, vcc
    v_cmp_eq_u32 vcc, 3, v35
    s_nop 1
    v_cndmask_b32 v7, 0, v34, vcc
    v_mov_b32 v32, 0xff61b1e6
    v_mov_b32 v33, 0
    v_mov_b32 v28, 0
    v_mov_b32 v29, 0
    v_mov_b32 v30, 0
    v_mov_b32 v31, 0
    v_bfe_u32 v34, v0, 3, 1
    v_lshlrev_b32 v34, 8, v34
    v_and_or_b32 v34, v0, 48, v34
    s_mov_b32 s48, 0x3fb8aa3b
    v_mov_b32 v47, 1
    s_mov_b32 s50, 0
    s_mov_b32 s51, 2
    s_barrier
    ds_read_b128 v[8:11], v34 offset:0
    ds_read_b128 v[12:15], v34 offset:64
    ds_read_b128 v[16:19], v34 offset:128
    ds_read_b128 v[20:23], v34 offset:192
    v_mov_b32 v35, 0
    ds_read_b32 v35, v35 offset:516
    s_mov_b64 exec, 1
    ds_add_rtn_u32 v3, v0, v47 offset:512
    s_mov_b64 exec, -1
    s_waitcnt lgkmcnt(0)
    v_readfirstlane_b32 s92, v35
    s_add_u32 s93, s92, 2654435769
    s_bfe_u32 s94, s93, 524288
    s_bfe_u32 s95, s93, 524296
    s_bfe_u32 s96, s93, 524304
    s_bfe_u32 s97, s93, 524312
    v_mov_b32 v227, 0xffffff00
L_sloop:
    s_waitcnt lgkmcnt(0)
    v_readfirstlane_b32 s52, v3
    s_cmp_lt_u32 s52, 240
    s_cbranch_scc1 L_tk0
    s_cmp_eq_u32 s50, 1
    s_cbranch_scc1 L_ex0
    s_sub_u32 s54, s52, 240
    s_lshr_b32 s54, s54, 2
    s_lshl_b32 s54, s54, 2
    v_mov_b32 v34, s54
    s_mov_b32 s57, 4000000
L_dw0:
    ds_read_b32 v35, v34 offset:15360
    s_sub_u32 s57, s57, 1
    s_cmp_eq_u32 s57, 0
    s_cbranch_scc1 L_ex0
    s_waitcnt lgkmcnt(0)
    v_readfirstlane_b32 s56, v35
    s_cmp_eq_u32 s56, -1
    s_cbranch_scc1 L_dw0
    s_cmp_ge_u32 s56, 32
    s_cbranch_scc1 L_ex0
    s_and_b32 s53, s56, 7
    s_lshl_b32 s53, s53, 20
    s_lshr_b32 s56, s56, 3
    s_lshl_b32 s56, s56, 2
    s_and_b32 s52, s52, 3
    s_add_u32 s52, s52, s56
    s_add_u32 s52, s52, 240
    s_branch L_tk0
L_ex0:
    v_mov_b32 v1, 0x7f000000
    v_mov_b32 v2, 0x7f000000
    s_cmp_eq_u32 s51, 1
    s_cselect_b32 s49, 1, 0
    s_mov_b32 s50, 1
    s_mov_b32 s52, 0
L_tk0:
    s_mov_b64 exec, 1
    ds_add_rtn_u32 v3, v0, v47 offset:512
    s_mov_b64 exec, -1
    s_bfe_u32 s54, s52, 65536
    s_lshl_b32 s54, s54, 11
    s_add_u32 s41, s53, s54
    s_bfe_u32 s54, s52, 65537
    s_lshl_b32 s54, s54, 14
    s_add_u32 s41, s41, s54
    s_bfe_u32 s54, s52, 65538
    s_lshl_b32 s54, s54, 10
    s_add_u32 s41, s41, s54
    s_bfe_u32 s54, s52, 65539
    s_lshl_b32 s54, s54, 12
    s_add_u32 s41, s41, s54
    s_bfe_u32 s54, s52, 65540
    s_lshl_b32 s54, s54, 15
    s_add_u32 s41, s41, s54
    s_bfe_u32 s54, s52, 196613
    s_lshl_b32 s54, s54, 17
    s_add_u32 s41, s41, s54
    s_waitcnt vmcnt(12)
    v_mfma_f32_16x16x32_bf16 v[24:27], v[64:67], v[8:11], 0
    v_mfma_f32_16x16x32_bf16 v[24:27], v[68:71], v[12:15], v[24:27]
    v_mfma_f32_16x16x32_bf16 v[24:27], v[72:75], v[16:19], v[24:27]
    v_mfma_f32_16x16x32_bf16 v[24:27], v[76:79], v[20:23], v[24:27]
    buffer_load_dwordx4 v[64:67], v1, s[32:35], s41 offen offset:0 nt
    buffer_load_dwordx4 v[68:71], v1, s[32:35], s41 offen offset:64 nt
    buffer_load_dwordx4 v[72:75], v1, s[32:35], s41 offen offset:128 nt
    buffer_load_dwordx4 v[76:79], v1, s[32:35], s41 offen offset:192 nt
L_wkr0:
    s_nop 3
    v_cvt_pk_bf16_f32 v34, v24, v25
    v_cvt_pk_bf16_f32 v35, v26, v27
    v_lshlrev_b32 v36, 16, v34
    v_and_b32 v37, 0xffff0000, v34
    v_lshlrev_b32 v38, 16, v35
    v_and_b32 v39, 0xffff0000, v35
    v_mul_f32 v36, 0x3db504f3, v36
    v_mul_f32 v37, 0x3db504f3, v37
    v_mul_f32 v38, 0x3db504f3, v38
    v_mul_f32 v39, 0x3db504f3, v39
    v_cvt_pk_bf16_f32 v34, v36, v37
    v_cvt_pk_bf16_f32 v35, v38, v39
    v_lshlrev_b32 v36, 16, v34
    v_and_b32 v37, 0xffff0000, v34
    v_lshlrev_b32 v38, 16, v35
    v_and_b32 v39, 0xffff0000, v35
    v_max3_f32 v40, v36, v37, v38
    v_max3_f32 v40, v40, v39, v32
    v_mov_b32 v41, v40
    s_nop 1
    v_permlane16_swap_b32 v40, v41
    s_nop 0
    v_max_f32 v40, v40, v41
    v_mov_b32 v41, v40
    s_nop 1
    v_permlane32_swap_b32 v40, v41
    s_nop 0
    v_max_f32 v40, v40, v41
    v_sub_f32 v41, v32, v40
    v_mul_f32 v42, s48, v40
    v_mul_f32 v41, s48, v41
    v_mov_b32 v32, v40
    v_exp_f32 v41, v41
    v_fma_f32 v36, v36, s48, -v42
    v_fma_f32 v37, v37, s48, -v42
    v_fma_f32 v38, v38, s48, -v42
    v_fma_f32 v39, v39, s48, -v42
    v_exp_f32 v36, v36
    v_exp_f32 v37, v37
    v_exp_f32 v38, v38
    v_exp_f32 v39, v39
    v_mul_f32 v28, v28, v41
    v_mul_f32 v29, v29, v41
    v_mul_f32 v30, v30, v41
    v_mul_f32 v31, v31, v41
    v_cvt_pk_bf16_f32 v43, v36, v36
    v_cvt_pk_bf16_f32 v44, v37, v37
    v_cvt_pk_bf16_f32 v45, v38, v38
    v_cvt_pk_bf16_f32 v46, v39, v39
    v_and_b32 v48, v43, v4
    v_and_b32 v49, v43, v5
    v_and_b32 v50, v43, v6
    v_and_b32 v51, v43, v7
    v_and_b32 v52, v44, v4
    v_and_b32 v53, v44, v5
    v_and_b32 v54, v44, v6
    v_and_b32 v55, v44, v7
    v_and_b32 v56, v45, v4
    v_and_b32 v57, v45, v5
    v_and_b32 v58, v45, v6
    v_and_b32 v59, v45, v7
    v_and_b32 v60, v46, v4
    v_and_b32 v61, v46, v5
    v_and_b32 v62, v46, v6
    v_and_b32 v63, v46, v7
    v_fma_f32 v33, v33, v41, v36
    s_waitcnt vmcnt(12)
    v_mfma_f32_16x16x32_bf16 v[28:31], v[80:83], v[48:51], v[28:31]
    v_mfma_f32_16x16x32_bf16 v[28:31], v[84:87], v[52:55], v[28:31]
    v_mfma_f32_16x16x32_bf16 v[28:31], v[88:91], v[56:59], v[28:31]
    v_mfma_f32_16x16x32_bf16 v[28:31], v[92:95], v[60:63], v[28:31]
    buffer_load_dwordx4 v[80:83], v2, s[36:39], s41 offen offset:0 nt
    buffer_load_dwordx4 v[84:87], v2, s[36:39], s41 offen offset:256 nt
    buffer_load_dwordx4 v[88:91], v2, s[36:39], s41 offen offset:512 nt
    buffer_load_dwordx4 v[92:95], v2, s[36:39], s41 offen offset:768 nt
L_wvr0:
    v_add_f32 v42, v37, v38
    v_add_f32 v33, v33, v39
    s_sub_u32 s51, s51, s50
    v_add_f32 v33, v33, v42
    s_cmp_eq_u32 s51, 0
    s_cbranch_scc1 L_sdone
    s_waitcnt lgkmcnt(0)
    v_readfirstlane_b32 s52, v3
    s_cmp_lt_u32 s52, 240
    s_cbranch_scc1 L_tk1
    s_cmp_eq_u32 s50, 1
    s_cbranch_scc1 L_ex1
    s_sub_u32 s54, s52, 240
    s_lshr_b32 s54, s54, 2
    s_lshl_b32 s54, s54, 2
    v_mov_b32 v34, s54
    s_mov_b32 s57, 4000000
L_dw1:
    ds_read_b32 v35, v34 offset:15360
    s_sub_u32 s57, s57, 1
    s_cmp_eq_u32 s57, 0
    s_cbranch_scc1 L_ex1
    s_waitcnt lgkmcnt(0)
    v_readfirstlane_b32 s56, v35
    s_cmp_eq_u32 s56, -1
    s_cbranch_scc1 L_dw1
    s_cmp_ge_u32 s56, 32
    s_cbranch_scc1 L_ex1
    s_and_b32 s53, s56, 7
    s_lshl_b32 s53, s53, 20
    s_lshr_b32 s56, s56, 3
    s_lshl_b32 s56, s56, 2
    s_and_b32 s52, s52, 3
    s_add_u32 s52, s52, s56
    s_add_u32 s52, s52, 240
    s_branch L_tk1
L_ex1:
    v_mov_b32 v1, 0x7f000000
    v_mov_b32 v2, 0x7f000000
    s_cmp_eq_u32 s51, 1
    s_cselect_b32 s49, 1, 0
    s_mov_b32 s50, 1
    s_mov_b32 s52, 0
L_tk1:
    s_mov_b64 exec, 1
    ds_add_rtn_u32 v3, v0, v47 offset:512
    s_mov_b64 exec, -1
    s_bfe_u32 s54, s52, 65536
    s_lshl_b32 s54, s54, 11
    s_add_u32 s41, s53, s54
    s_bfe_u32 s54, s52, 65537
    s_lshl_b32 s54, s54, 14
    s_add_u32 s41, s41, s54
    s_bfe_u32 s54, s52, 65538
    s_lshl_b32 s54, s54, 10
    s_add_u32 s41, s41, s54
    s_bfe_u32 s54, s52, 65539
    s_lshl_b32 s54, s54, 12
    s_add_u32 s41, s41, s54
    s_bfe_u32 s54, s52, 65540
    s_lshl_b32 s54, s54, 15
    s_add_u32 s41, s41, s54
    s_bfe_u32 s54, s52, 196613
    s_lshl_b32 s54, s54, 17
    s_add_u32 s41, s41, s54
    s_waitcnt vmcnt(12)
    v_mfma_f32_16x16x32_bf16 v[24:27], v[96:99], v[8:11], 0
    v_mfma_f32_16x16x32_bf16 v[24:27], v[100:103], v[12:15], v[24:27]
    v_mfma_f32_16x16x32_bf16 v[24:27], v[104:107], v[16:19], v[24:27]
    v_mfma_f32_16x16x32_bf16 v[24:27], v[108:111], v[20:23], v[24:27]
    buffer_load_dwordx4 v[96:99], v1, s[32:35], s41 offen offset:0 nt
    buffer_load_dwordx4 v[100:103], v1, s[32:35], s41 offen offset:64 nt
    buffer_load_dwordx4 v[104:107], v1, s[32:35], s41 offen offset:128 nt
    buffer_load_dwordx4 v[108:111], v1, s[32:35], s41 offen offset:192 nt
L_wkr1:
    s_nop 3
    v_cvt_pk_bf16_f32 v34, v24, v25
    v_cvt_pk_bf16_f32 v35, v26, v27
    v_lshlrev_b32 v36, 16, v34
    v_and_b32 v37, 0xffff0000, v34
    v_lshlrev_b32 v38, 16, v35
    v_and_b32 v39, 0xffff0000, v35
    v_mul_f32 v36, 0x3db504f3, v36
    v_mul_f32 v37, 0x3db504f3, v37
    v_mul_f32 v38, 0x3db504f3, v38
    v_mul_f32 v39, 0x3db504f3, v39
    v_cvt_pk_bf16_f32 v34, v36, v37
    v_cvt_pk_bf16_f32 v35, v38, v39
    v_lshlrev_b32 v36, 16, v34
    v_and_b32 v37, 0xffff0000, v34
    v_lshlrev_b32 v38, 16, v35
    v_and_b32 v39, 0xffff0000, v35
    v_max3_f32 v40, v36, v37, v38
    v_max3_f32 v40, v40, v39, v32
    v_mov_b32 v41, v40
    s_nop 1
    v_permlane16_swap_b32 v40, v41
    s_nop 0
    v_max_f32 v40, v40, v41
    v_mov_b32 v41, v40
    s_nop 1
    v_permlane32_swap_b32 v40, v41
    s_nop 0
    v_max_f32 v40, v40, v41
    v_sub_f32 v41, v32, v40
    v_mul_f32 v42, s48, v40
    v_mul_f32 v41, s48, v41
    v_mov_b32 v32, v40
    v_exp_f32 v41, v41
    v_fma_f32 v36, v36, s48, -v42
    v_fma_f32 v37, v37, s48, -v42
    v_fma_f32 v38, v38, s48, -v42
    v_fma_f32 v39, v39, s48, -v42
    v_exp_f32 v36, v36
    v_exp_f32 v37, v37
    v_exp_f32 v38, v38
    v_exp_f32 v39, v39
    v_mul_f32 v28, v28, v41
    v_mul_f32 v29, v29, v41
    v_mul_f32 v30, v30, v41
    v_mul_f32 v31, v31, v41
    v_cvt_pk_bf16_f32 v43, v36, v36
    v_cvt_pk_bf16_f32 v44, v37, v37
    v_cvt_pk_bf16_f32 v45, v38, v38
    v_cvt_pk_bf16_f32 v46, v39, v39
    v_and_b32 v48, v43, v4
    v_and_b32 v49, v43, v5
    v_and_b32 v50, v43, v6
    v_and_b32 v51, v43, v7
    v_and_b32 v52, v44, v4
    v_and_b32 v53, v44, v5
    v_and_b32 v54, v44, v6
    v_and_b32 v55, v44, v7
    v_and_b32 v56, v45, v4
    v_and_b32 v57, v45, v5
    v_and_b32 v58, v45, v6
    v_and_b32 v59, v45, v7
    v_and_b32 v60, v46, v4
    v_and_b32 v61, v46, v5
    v_and_b32 v62, v46, v6
    v_and_b32 v63, v46, v7
    v_fma_f32 v33, v33, v41, v36
    s_waitcnt vmcnt(12)
    v_mfma_f32_16x16x32_bf16 v[28:31], v[112:115], v[48:51], v[28:31]
    v_mfma_f32_16x16x32_bf16 v[28:31], v[116:119], v[52:55], v[28:31]
    v_mfma_f32_16x16x32_bf16 v[28:31], v[120:123], v[56:59], v[28:31]
    v_mfma_f32_16x16x32_bf16 v[28:31], v[124:127], v[60:63], v[28:31]
    buffer_load_dwordx4 v[112:115], v2, s[36:39], s41 offen offset:0 nt
    buffer_load_dwordx4 v[116:119], v2, s[36:39], s41 offen offset:256 nt
    buffer_load_dwordx4 v[120:123], v2, s[36:39], s41 offen offset:512 nt
    buffer_load_dwordx4 v[124:127], v2, s[36:39], s41 offen offset:768 nt
L_wvr1:
    v_add_f32 v42, v37, v38
    v_add_f32 v33, v33, v39
    s_sub_u32 s51, s51, s50
    v_add_f32 v33, v33, v42
    s_cmp_eq_u32 s51, 0
    s_cbranch_scc0 L_sloop
L_sdone:
    s_lshl_b32 s43, s42, 10
    v_lshl_add_u32 v35, v0, 4, s43
    s_lshl_b32 s43, s42, 9
    v_lshl_add_u32 v36, v0, 3, s43
    ds_write_b128 v35, v[28:31] offset:9216
    v_mov_b32 v34, v33
    s_nop 1
    v_permlane16_swap_b32 v33, v34
    s_nop 0
    v_add_f32 v33, v33, v34
    v_mov_b32 v34, v33
    s_nop 1
    v_permlane32_swap_b32 v33, v34
    s_nop 0
    v_add_f32 v33, v33, v34
    ds_write_b64 v36, v[32:33] offset:13312
    s_waitcnt lgkmcnt(0)
    v_lshlrev_b32 v2, 3, v0
    s_barrier
    v_mov_b32 v1, 0
    ds_read_b32 v1, v1 offset:520
    s_waitcnt lgkmcnt(0)
    v_xor_b32 v226, v226, v1
    s_setprio 3
    s_waitcnt vmcnt(0)
    s_mov_b32 s57, 32000000
L_pkw:
    ds_read_b32 v1, v2 offset:3584
    s_sub_u32 s57, s57, 1
    s_waitcnt lgkmcnt(0)
    v_cmp_eq_u32 vcc, 1, v1
    s_cbranch_vccz L_tail3
    s_cmp_lg_u32 s57, 0
    s_cbranch_scc1 L_pkw
    s_branch L_tail3
L_hf:
    s_barrier
    s_add_u32 s33, s4, s5
    s_and_b32 s33, s33, 7
    s_lshl_b32 s33, s33, 5
    s_add_u32 s82, s33, s4
    v_lshrrev_b32 v25, 4, v0
    v_and_b32 v1, 15, v0
    v_and_b32 v26, 7, v0
    v_bfe_u32 v27, v0, 3, 1
    v_lshlrev_b32 v1, 4, v1
    s_waitcnt lgkmcnt(0)
    s_mov_b32 s44, s30
    s_mov_b32 s45, s31
    s_mov_b32 s46, 4194304
    s_mov_b32 s47, 0x20000
    s_cmp_lt_u32 s82, 216
    s_cbranch_scc1 L_st1
    s_cmp_lt_u32 s82, 240
    s_cbranch_scc1 L_no1
    s_cmp_eq_u32 s82, 255
    s_cbranch_scc1 L_probe
    s_endpgm
L_probe:
    s_add_u32 s36, s30, 819200
    s_addc_u32 s37, s31, 0
    s_barrier
    v_mov_b32 v2, 0
    ds_read_b32 v2, v2 offset:516
    s_waitcnt lgkmcnt(0)
    v_readfirstlane_b32 s92, v2
    s_add_u32 s93, s92, 2654435769
    s_bfe_u32 s94, s93, 524288
    s_bfe_u32 s95, s93, 524296
    s_bfe_u32 s96, s93, 524304
    s_bfe_u32 s97, s93, 524312
    v_mov_b32 v22, 0xffffff00
    s_mov_b32 s40, 0
    s_mov_b32 s41, 5
L_prl:
    s_memtime s[48:49]
    s_mov_b32 s42, 0
    s_waitcnt lgkmcnt(0)
    s_atomic_add s42, s[36:37], 0 glc
    s_waitcnt lgkmcnt(0)
    s_memtime s[50:51]
    s_waitcnt lgkmcnt(0)
    s_sub_u32 s42, s50, s48
    s_min_u32 s42, s42, 4000
    s_sub_u32 s40, s40, s42
    s_memtime s[48:49]
    s_mov_b32 s42, 0
    s_waitcnt lgkmcnt(0)
    s_atomic_add s42, s[36:37], 8192 glc
    s_waitcnt lgkmcnt(0)
    s_memtime s[50:51]
    s_waitcnt lgkmcnt(0)
    s_sub_u32 s42, s50, s48
    s_min_u32 s42, s42, 4000
    s_add_u32 s40, s40, s42
    s_memtime s[48:49]
    s_mov_b32 s42, 0
    s_waitcnt lgkmcnt(0)
    s_atomic_add s42, s[36:37], 4096 glc
    s_waitcnt lgkmcnt(0)
    s_memtime s[50:51]
    s_waitcnt lgkmcnt(0)
    s_sub_u32 s42, s50, s48
    s_min_u32 s42, s42, 4000
    s_sub_u32 s40, s40, s42
    s_memtime s[48:49]
    s_mov_b32 s42, 0
    s_waitcnt lgkmcnt(0)
    s_atomic_add s42, s[36:37], 12288 glc
    s_waitcnt lgkmcnt(0)
    s_memtime s[50:51]
    s_waitcnt lgkmcnt(0)
    s_sub_u32 s42, s50, s48
    s_min_u32 s42, s42, 4000
    s_add_u32 s40, s40, s42
    s_memtime s[48:49]
    s_mov_b32 s42, 0
    s_waitcnt lgkmcnt(0)
    s_atomic_add s42, s[36:37], 16384 glc
    s_waitcnt lgkmcnt(0)
    s_memtime s[50:51]
    s_waitcnt lgkmcnt(0)
    s_sub_u32 s42, s50, s48
    s_min_u32 s42, s42, 4000
    s_sub_u32 s40, s40, s42
    s_memtime s[48:49]
    s_mov_b32 s42, 0
    s_waitcnt lgkmcnt(0)
    s_atomic_add s42, s[36:37], 24576 glc
    s_waitcnt lgkmcnt(0)
    s_memtime s[50:51]
    s_waitcnt lgkmcnt(0)
    s_sub_u32 s42, s50, s48
    s_min_u32 s42, s42, 4000
    s_add_u32 s40, s40, s42
    s_memtime s[48:49]
    s_mov_b32 s42, 0
    s_waitcnt lgkmcnt(0)
    s_atomic_add s42, s[36:37], 20480 glc
    s_waitcnt lgkmcnt(0)
    s_memtime s[50:51]
    s_waitcnt lgkmcnt(0)
    s_sub_u32 s42, s50, s48
    s_min_u32 s42, s42, 4000
    s_sub_u32 s40, s40, s42
    s_memtime s[48:49]
    s_mov_b32 s42, 0
    s_waitcnt lgkmcnt(0)
    s_atomic_add s42, s[36:37], 28672 glc
    s_waitcnt lgkmcnt(0)
    s_memtime s[50:51]
    s_waitcnt lgkmcnt(0)
    s_sub_u32 s42, s50, s48
    s_min_u32 s42, s42, 4000
    s_add_u32 s40, s40, s42
    s_cmp_eq_u32 s41, 5
    s_cselect_b32 s40, 0, s40
    s_sub_u32 s41, s41, 1
    s_cmp_lg_u32 s41, 0
    s_cbranch_scc1 L_prl
    s_lshr_b32 s42, s40, 31
    v_mov_b32 v2, s42
    v_mov_b32 v3, s93
    s_mov_b32 s41, 790528
    s_mov_b64 exec, 1
    buffer_store_dwordx2 v[2:3], off, s[44:47], s41 sc1
    s_endpgm
L_no1:
    s_barrier
    v_and_b32 v2, 1, v0
    v_lshlrev_b32 v2, 4, v2
    v_mov_b32 v3, 0xffff
    v_lshlrev_b32 v2, v2, v3
    v_bfe_u32 v3, v0, 1, 2
    v_cmp_eq_u32 vcc, 0, v3
    s_nop 1
    v_cndmask_b32 v4, 0, v2, vcc
    v_cmp_eq_u32 vcc, 1, v3
    s_nop 1
    v_cndmask_b32 v5, 0, v2, vcc
    v_cmp_eq_u32 vcc, 2, v3
    s_nop 1
    v_cndmask_b32 v6, 0, v2, vcc
    v_cmp_eq_u32 vcc, 3, v3
    s_nop 1
    v_cndmask_b32 v7, 0, v2, vcc
    v_mov_b32 v2, 0
    ds_read_b32 v2, v2 offset:516
    s_waitcnt lgkmcnt(0)
    v_readfirstlane_b32 s92, v2
    s_add_u32 s93, s92, 2654435769
    s_bfe_u32 s94, s93, 524288
    s_bfe_u32 s95, s93, 524296
    s_bfe_u32 s96, s93, 524304
    s_bfe_u32 s97, s93, 524312
    v_mov_b32 v22, 0xffffff00
    s_branch L_st2
L_st1:
    s_mul_i32 s42, s82, 0x5556
    s_lshr_b32 s42, s42, 16
    s_mul_i32 s43, s42, 3
    s_sub_u32 s43, s82, s43
    s_cmp_ge_u32 s42, 36
    s_cselect_b32 s59, 1, 0
    s_cselect_b32 s36, s22, s20
    s_cselect_b32 s37, s23, s21
    s_mov_b32 s38, 5308416
    s_mov_b32 s39, 0x20000
    s_mul_i32 s40, s59, 36
    s_sub_u32 s42, s42, s40
    s_mul_i32 s40, s43, 1769472
    s_lshl_b32 s41, s42, 8
    s_add_u32 s40, s40, s41
    v_mul_u32_u24 v20, 442368, v25
    v_add3_u32 v20, v20, v1, s40
    s_mov_b32 s40, 0
    buffer_load_dwordx4 v[64:67], v20, s[36:39], s40 offen nt
    s_mov_b32 s40, 9216
    buffer_load_dwordx4 v[68:71], v20, s[36:39], s40 offen nt
    s_mov_b32 s40, 18432
    buffer_load_dwordx4 v[72:75], v20, s[36:39], s40 offen nt
    s_mov_b32 s40, 27648
    buffer_load_dwordx4 v[76:79], v20, s[36:39], s40 offen nt
    s_mov_b32 s40, 36864
    buffer_load_dwordx4 v[80:83], v20, s[36:39], s40 offen nt
    s_mov_b32 s40, 46080
    buffer_load_dwordx4 v[84:87], v20, s[36:39], s40 offen nt
    s_mov_b32 s40, 55296
    buffer_load_dwordx4 v[88:91], v20, s[36:39], s40 offen nt
    s_mov_b32 s40, 64512
    buffer_load_dwordx4 v[92:95], v20, s[36:39], s40 offen nt
    s_mov_b32 s40, 73728
    buffer_load_dwordx4 v[96:99], v20, s[36:39], s40 offen nt
    s_mov_b32 s40, 82944
    buffer_load_dwordx4 v[100:103], v20, s[36:39], s40 offen nt
    s_mov_b32 s40, 92160
    buffer_load_dwordx4 v[104:107], v20, s[36:39], s40 offen nt
    s_mov_b32 s40, 101376
    buffer_load_dwordx4 v[108:111], v20, s[36:39], s40 offen nt
    s_mov_b32 s40, 110592
    buffer_load_dwordx4 v[112:115], v20, s[36:39], s40 offen nt
    s_mov_b32 s40, 119808
    buffer_load_dwordx4 v[116:119], v20, s[36:39], s40 offen nt
    s_mov_b32 s40, 129024
    buffer_load_dwordx4 v[120:123], v20, s[36:39], s40 offen nt
    s_mov_b32 s40, 138240
    buffer_load_dwordx4 v[124:127], v20, s[36:39], s40 offen nt
    s_mov_b32 s40, 147456
    buffer_load_dwordx4 v[128:131], v20, s[36:39], s40 offen nt
    s_mov_b32 s40, 156672
    buffer_load_dwordx4 v[132:135], v20, s[36:39], s40 offen nt
    s_mov_b32 s40, 165888
    buffer_load_dwordx4 v[136:139], v20, s[36:39], s40 offen nt
    s_mov_b32 s40, 175104
    buffer_load_dwordx4 v[140:143], v20, s[36:39], s40 offen nt
    s_mov_b32 s40, 184320
    buffer_load_dwordx4 v[144:147], v20, s[36:39], s40 offen nt
    s_mov_b32 s40, 193536
    buffer_load_dwordx4 v[148:151], v20, s[36:39], s40 offen nt
    s_mov_b32 s40, 202752
    buffer_load_dwordx4 v[152:155], v20, s[36:39], s40 offen nt
    s_mov_b32 s40, 211968
    buffer_load_dwordx4 v[156:159], v20, s[36:39], s40 offen nt
    s_mov_b32 s40, 221184
    buffer_load_dwordx4 v[160:163], v20, s[36:39], s40 offen nt
    s_mov_b32 s40, 230400
    buffer_load_dwordx4 v[164:167], v20, s[36:39], s40 offen nt
    s_mov_b32 s40, 239616
    buffer_load_dwordx4 v[168:171], v20, s[36:39], s40 offen nt
    s_mov_b32 s40, 248832
    buffer_load_dwordx4 v[172:175], v20, s[36:39], s40 offen nt
    s_mov_b32 s40, 258048
    buffer_load_dwordx4 v[176:179], v20, s[36:39], s40 offen nt
    s_mov_b32 s40, 267264
    buffer_load_dwordx4 v[180:183], v20, s[36:39], s40 offen nt
    s_mov_b32 s40, 276480
    buffer_load_dwordx4 v[184:187], v20, s[36:39], s40 offen nt
    s_mov_b32 s40, 285696
    buffer_load_dwordx4 v[188:191], v20, s[36:39], s40 offen nt
    s_mov_b32 s40, 294912
    buffer_load_dwordx4 v[192:195], v20, s[36:39], s40 offen nt
    s_mov_b32 s40, 304128
    buffer_load_dwordx4 v[196:199], v20, s[36:39], s40 offen nt
    s_mov_b32 s40, 313344
    buffer_load_dwordx4 v[200:203], v20, s[36:39], s40 offen nt
    s_mov_b32 s40, 322560
    buffer_load_dwordx4 v[204:207], v20, s[36:39], s40 offen nt
    s_mov_b32 s40, 331776
    buffer_load_dwordx4 v[208:211], v20, s[36:39], s40 offen nt
    s_mov_b32 s40, 340992
    buffer_load_dwordx4 v[212:215], v20, s[36:39], s40 offen nt
    s_mov_b32 s40, 350208
    buffer_load_dwordx4 v[216:219], v20, s[36:39], s40 offen nt
    s_mov_b32 s40, 359424
    buffer_load_dwordx4 v[220:223], v20, s[36:39], s40 offen nt
    s_mov_b32 s40, 368640
    buffer_load_dwordx4 v[224:227], v20, s[36:39], s40 offen nt
    s_mov_b32 s40, 377856
    buffer_load_dwordx4 v[228:231], v20, s[36:39], s40 offen nt
    s_mov_b32 s40, 387072
    buffer_load_dwordx4 v[232:235], v20, s[36:39], s40 offen nt
    s_mov_b32 s40, 396288
    buffer_load_dwordx4 v[236:239], v20, s[36:39], s40 offen nt
    s_mov_b32 s40, 405504
    buffer_load_dwordx4 v[240:243], v20, s[36:39], s40 offen nt
    s_mov_b32 s40, 414720
    buffer_load_dwordx4 v[244:247], v20, s[36:39], s40 offen nt
    s_mov_b32 s40, 423936
    buffer_load_dwordx4 v[248:251], v20, s[36:39], s40 offen nt
    s_mov_b32 s40, 433152
    buffer_load_dwordx4 v[252:255], v20, s[36:39], s40 offen nt
    s_barrier
    s_mul_i32 s40, s43, 384
    v_mul_u32_u24 v24, 96, v25
    v_mul_u32_u24 v2, 1152, v27
    v_add3_u32 v24, v24, v2, s40
    ds_read_b128 v[28:31], v24 offset:1024
    ds_read_b128 v[32:35], v24 offset:1040
    ds_read_b128 v[36:39], v24 offset:1056
    ds_read_b128 v[40:43], v24 offset:1072
    ds_read_b128 v[44:47], v24 offset:1088
    ds_read_b128 v[48:51], v24 offset:1104
    s_mul_i32 s40, s59, 3
    s_add_u32 s40, s40, s43
    s_mul_i32 s40, s40, 36864
    s_lshl_b32 s41, s42, 9
    s_add_u32 s40, s40, s41
    s_add_u32 s40, s40, 2097152
    v_lshl_add_u32 v21, v25, 3, v26
    v_lshlrev_b32 v21, 4, v21
    v_mul_u32_u24 v2, 18432, v27
    v_add3_u32 v21, v21, v2, s40
    v_and_b32 v2, 1, v0
    v_lshlrev_b32 v2, 4, v2
    v_mov_b32 v3, 0xffff
    v_lshlrev_b32 v2, v2, v3
    v_bfe_u32 v3, v0, 1, 2
    v_cmp_eq_u32 vcc, 0, v3
    s_nop 1
    v_cndmask_b32 v4, 0, v2, vcc
    v_cmp_eq_u32 vcc, 1, v3
    s_nop 1
    v_cndmask_b32 v5, 0, v2, vcc
    v_cmp_eq_u32 vcc, 2, v3
    s_nop 1
    v_cndmask_b32 v6, 0, v2, vcc
    v_cmp_eq_u32 vcc, 3, v3
    s_nop 1
    v_cndmask_b32 v7, 0, v2, vcc
    v_mov_b32 v2, 0
    ds_read_b32 v2, v2 offset:516
    s_waitcnt lgkmcnt(0)
    v_readfirstlane_b32 s92, v2
    s_add_u32 s93, s92, 2654435769
    s_bfe_u32 s94, s93, 524288
    s_bfe_u32 s95, s93, 524296
    s_bfe_u32 s96, s93, 524304
    s_bfe_u32 s97, s93, 524312
    v_mov_b32 v22, 0xffffff00
    s_mov_b32 s40, 0x01000100
    s_mov_b32 s41, 0x03020302
    v_perm_b32 v1, v28, v28, s40
    v_and_b32 v8, v1, v4
    v_and_b32 v9, v1, v5
    v_and_b32 v10, v1, v6
    v_and_b32 v11, v1, v7
    s_waitcnt vmcnt(47)
    s_nop 0
    v_mfma_f32_16x16x32_bf16 v[16:19], v[64:67], v[8:11], 0
    v_perm_b32 v1, v28, v28, s41
    v_and_b32 v12, v1, v4
    v_and_b32 v13, v1, v5
    v_and_b32 v14, v1, v6
    v_and_b32 v15, v1, v7
    s_waitcnt vmcnt(46)
    s_nop 0
    v_mfma_f32_16x16x32_bf16 v[16:19], v[68:71], v[12:15], v[16:19]
    v_perm_b32 v1, v29, v29, s40
    v_and_b32 v8, v1, v4
    v_and_b32 v9, v1, v5
    v_and_b32 v10, v1, v6
    v_and_b32 v11, v1, v7
    s_waitcnt vmcnt(45)
    s_nop 0
    v_mfma_f32_16x16x32_bf16 v[16:19], v[72:75], v[8:11], v[16:19]
    v_perm_b32 v1, v29, v29, s41
    v_and_b32 v12, v1, v4
    v_and_b32 v13, v1, v5
    v_and_b32 v14, v1, v6
    v_and_b32 v15, v1, v7
    s_waitcnt vmcnt(44)
    s_nop 0
    v_mfma_f32_16x16x32_bf16 v[16:19], v[76:79], v[12:15], v[16:19]
    v_perm_b32 v1, v30, v30, s40
    v_and_b32 v8, v1, v4
    v_and_b32 v9, v1, v5
    v_and_b32 v10, v1, v6
    v_and_b32 v11, v1, v7
    s_waitcnt vmcnt(43)
    s_nop 0
    v_mfma_f32_16x16x32_bf16 v[16:19], v[80:83], v[8:11], v[16:19]
    v_perm_b32 v1, v30, v30, s41
    v_and_b32 v12, v1, v4
    v_and_b32 v13, v1, v5
    v_and_b32 v14, v1, v6
    v_and_b32 v15, v1, v7
    s_waitcnt vmcnt(42)
    s_nop 0
    v_mfma_f32_16x16x32_bf16 v[16:19], v[84:87], v[12:15], v[16:19]
    v_perm_b32 v1, v31, v31, s40
    v_and_b32 v8, v1, v4
    v_and_b32 v9, v1, v5
    v_and_b32 v10, v1, v6
    v_and_b32 v11, v1, v7
    s_waitcnt vmcnt(41)
    s_nop 0
    v_mfma_f32_16x16x32_bf16 v[16:19], v[88:91], v[8:11], v[16:19]
    v_perm_b32 v1, v31, v31, s41
    v_and_b32 v12, v1, v4
    v_and_b32 v13, v1, v5
    v_and_b32 v14, v1, v6
    v_and_b32 v15, v1, v7
    s_waitcnt vmcnt(40)
    s_nop 0
    v_mfma_f32_16x16x32_bf16 v[16:19], v[92:95], v[12:15], v[16:19]
    v_perm_b32 v1, v32, v32, s40
    v_and_b32 v8, v1, v4
    v_and_b32 v9, v1, v5
    v_and_b32 v10, v1, v6
    v_and_b32 v11, v1, v7
    s_waitcnt vmcnt(39)
    s_nop 0
    v_mfma_f32_16x16x32_bf16 v[16:19], v[96:99], v[8:11], v[16:19]
    v_perm_b32 v1, v32, v32, s41
    v_and_b32 v12, v1, v4
    v_and_b32 v13, v1, v5
    v_and_b32 v14, v1, v6
    v_and_b32 v15, v1, v7
    s_waitcnt vmcnt(38)
    s_nop 0
    v_mfma_f32_16x16x32_bf16 v[16:19], v[100:103], v[12:15], v[16:19]
    v_perm_b32 v1, v33, v33, s40
    v_and_b32 v8, v1, v4
    v_and_b32 v9, v1, v5
    v_and_b32 v10, v1, v6
    v_and_b32 v11, v1, v7
    s_waitcnt vmcnt(37)
    s_nop 0
    v_mfma_f32_16x16x32_bf16 v[16:19], v[104:107], v[8:11], v[16:19]
    v_perm_b32 v1, v33, v33, s41
    v_and_b32 v12, v1, v4
    v_and_b32 v13, v1, v5
    v_and_b32 v14, v1, v6
    v_and_b32 v15, v1, v7
    s_waitcnt vmcnt(36)
    s_nop 0
    v_mfma_f32_16x16x32_bf16 v[16:19], v[108:111], v[12:15], v[16:19]
    v_perm_b32 v1, v34, v34, s40
    v_and_b32 v8, v1, v4
    v_and_b32 v9, v1, v5
    v_and_b32 v10, v1, v6
    v_and_b32 v11, v1, v7
    s_waitcnt vmcnt(35)
    s_nop 0
    v_mfma_f32_16x16x32_bf16 v[16:19], v[112:115], v[8:11], v[16:19]
    v_perm_b32 v1, v34, v34, s41
    v_and_b32 v12, v1, v4
    v_and_b32 v13, v1, v5
    v_and_b32 v14, v1, v6
    v_and_b32 v15, v1, v7
    s_waitcnt vmcnt(34)
    s_nop 0
    v_mfma_f32_16x16x32_bf16 v[16:19], v[116:119], v[12:15], v[16:19]
    v_perm_b32 v1, v35, v35, s40
    v_and_b32 v8, v1, v4
    v_and_b32 v9, v1, v5
    v_and_b32 v10, v1, v6
    v_and_b32 v11, v1, v7
    s_waitcnt vmcnt(33)
    s_nop 0
    v_mfma_f32_16x16x32_bf16 v[16:19], v[120:123], v[8:11], v[16:19]
    v_perm_b32 v1, v35, v35, s41
    v_and_b32 v12, v1, v4
    v_and_b32 v13, v1, v5
    v_and_b32 v14, v1, v6
    v_and_b32 v15, v1, v7
    s_waitcnt vmcnt(32)
    s_nop 0
    v_mfma_f32_16x16x32_bf16 v[16:19], v[124:127], v[12:15], v[16:19]
    v_perm_b32 v1, v36, v36, s40
    v_and_b32 v8, v1, v4
    v_and_b32 v9, v1, v5
    v_and_b32 v10, v1, v6
    v_and_b32 v11, v1, v7
    s_waitcnt vmcnt(31)
    s_nop 0
    v_mfma_f32_16x16x32_bf16 v[16:19], v[128:131], v[8:11], v[16:19]
    v_perm_b32 v1, v36, v36, s41
    v_and_b32 v12, v1, v4
    v_and_b32 v13, v1, v5
    v_and_b32 v14, v1, v6
    v_and_b32 v15, v1, v7
    s_waitcnt vmcnt(30)
    s_nop 0
    v_mfma_f32_16x16x32_bf16 v[16:19], v[132:135], v[12:15], v[16:19]
    v_perm_b32 v1, v37, v37, s40
    v_and_b32 v8, v1, v4
    v_and_b32 v9, v1, v5
    v_and_b32 v10, v1, v6
    v_and_b32 v11, v1, v7
    s_waitcnt vmcnt(29)
    s_nop 0
    v_mfma_f32_16x16x32_bf16 v[16:19], v[136:139], v[8:11], v[16:19]
    v_perm_b32 v1, v37, v37, s41
    v_and_b32 v12, v1, v4
    v_and_b32 v13, v1, v5
    v_and_b32 v14, v1, v6
    v_and_b32 v15, v1, v7
    s_waitcnt vmcnt(28)
    s_nop 0
    v_mfma_f32_16x16x32_bf16 v[16:19], v[140:143], v[12:15], v[16:19]
    v_perm_b32 v1, v38, v38, s40
    v_and_b32 v8, v1, v4
    v_and_b32 v9, v1, v5
    v_and_b32 v10, v1, v6
    v_and_b32 v11, v1, v7
    s_waitcnt vmcnt(27)
    s_nop 0
    v_mfma_f32_16x16x32_bf16 v[16:19], v[144:147], v[8:11], v[16:19]
    v_perm_b32 v1, v38, v38, s41
    v_and_b32 v12, v1, v4
    v_and_b32 v13, v1, v5
    v_and_b32 v14, v1, v6
    v_and_b32 v15, v1, v7
    s_waitcnt vmcnt(26)
    s_nop 0
    v_mfma_f32_16x16x32_bf16 v[16:19], v[148:151], v[12:15], v[16:19]
    v_perm_b32 v1, v39, v39, s40
    v_and_b32 v8, v1, v4
    v_and_b32 v9, v1, v5
    v_and_b32 v10, v1, v6
    v_and_b32 v11, v1, v7
    s_waitcnt vmcnt(25)
    s_nop 0
    v_mfma_f32_16x16x32_bf16 v[16:19], v[152:155], v[8:11], v[16:19]
    v_perm_b32 v1, v39, v39, s41
    v_and_b32 v12, v1, v4
    v_and_b32 v13, v1, v5
    v_and_b32 v14, v1, v6
    v_and_b32 v15, v1, v7
    s_waitcnt vmcnt(24)
    s_nop 0
    v_mfma_f32_16x16x32_bf16 v[16:19], v[156:159], v[12:15], v[16:19]
    v_perm_b32 v1, v40, v40, s40
    v_and_b32 v8, v1, v4
    v_and_b32 v9, v1, v5
    v_and_b32 v10, v1, v6
    v_and_b32 v11, v1, v7
    s_waitcnt vmcnt(23)
    s_nop 0
    v_mfma_f32_16x16x32_bf16 v[16:19], v[160:163], v[8:11], v[16:19]
    v_perm_b32 v1, v40, v40, s41
    v_and_b32 v12, v1, v4
    v_and_b32 v13, v1, v5
    v_and_b32 v14, v1, v6
    v_and_b32 v15, v1, v7
    s_waitcnt vmcnt(22)
    s_nop 0
    v_mfma_f32_16x16x32_bf16 v[16:19], v[164:167], v[12:15], v[16:19]
    v_perm_b32 v1, v41, v41, s40
    v_and_b32 v8, v1, v4
    v_and_b32 v9, v1, v5
    v_and_b32 v10, v1, v6
    v_and_b32 v11, v1, v7
    s_waitcnt vmcnt(21)
    s_nop 0
    v_mfma_f32_16x16x32_bf16 v[16:19], v[168:171], v[8:11], v[16:19]
    v_perm_b32 v1, v41, v41, s41
    v_and_b32 v12, v1, v4
    v_and_b32 v13, v1, v5
    v_and_b32 v14, v1, v6
    v_and_b32 v15, v1, v7
    s_waitcnt vmcnt(20)
    s_nop 0
    v_mfma_f32_16x16x32_bf16 v[16:19], v[172:175], v[12:15], v[16:19]
    v_perm_b32 v1, v42, v42, s40
    v_and_b32 v8, v1, v4
    v_and_b32 v9, v1, v5
    v_and_b32 v10, v1, v6
    v_and_b32 v11, v1, v7
    s_waitcnt vmcnt(19)
    s_nop 0
    v_mfma_f32_16x16x32_bf16 v[16:19], v[176:179], v[8:11], v[16:19]
    v_perm_b32 v1, v42, v42, s41
    v_and_b32 v12, v1, v4
    v_and_b32 v13, v1, v5
    v_and_b32 v14, v1, v6
    v_and_b32 v15, v1, v7
    s_waitcnt vmcnt(18)
    s_nop 0
    v_mfma_f32_16x16x32_bf16 v[16:19], v[180:183], v[12:15], v[16:19]
    v_perm_b32 v1, v43, v43, s40
    v_and_b32 v8, v1, v4
    v_and_b32 v9, v1, v5
    v_and_b32 v10, v1, v6
    v_and_b32 v11, v1, v7
    s_waitcnt vmcnt(17)
    s_nop 0
    v_mfma_f32_16x16x32_bf16 v[16:19], v[184:187], v[8:11], v[16:19]
    v_perm_b32 v1, v43, v43, s41
    v_and_b32 v12, v1, v4
    v_and_b32 v13, v1, v5
    v_and_b32 v14, v1, v6
    v_and_b32 v15, v1, v7
    s_waitcnt vmcnt(16)
    s_nop 0
    v_mfma_f32_16x16x32_bf16 v[16:19], v[188:191], v[12:15], v[16:19]
    v_perm_b32 v1, v44, v44, s40
    v_and_b32 v8, v1, v4
    v_and_b32 v9, v1, v5
    v_and_b32 v10, v1, v6
    v_and_b32 v11, v1, v7
    s_waitcnt vmcnt(15)
    s_nop 0
    v_mfma_f32_16x16x32_bf16 v[16:19], v[192:195], v[8:11], v[16:19]
    v_perm_b32 v1, v44, v44, s41
    v_and_b32 v12, v1, v4
    v_and_b32 v13, v1, v5
    v_and_b32 v14, v1, v6
    v_and_b32 v15, v1, v7
    s_waitcnt vmcnt(14)
    s_nop 0
    v_mfma_f32_16x16x32_bf16 v[16:19], v[196:199], v[12:15], v[16:19]
    v_perm_b32 v1, v45, v45, s40
    v_and_b32 v8, v1, v4
    v_and_b32 v9, v1, v5
    v_and_b32 v10, v1, v6
    v_and_b32 v11, v1, v7
    s_waitcnt vmcnt(13)
    s_nop 0
    v_mfma_f32_16x16x32_bf16 v[16:19], v[200:203], v[8:11], v[16:19]
    v_perm_b32 v1, v45, v45, s41
    v_and_b32 v12, v1, v4
    v_and_b32 v13, v1, v5
    v_and_b32 v14, v1, v6
    v_and_b32 v15, v1, v7
    s_waitcnt vmcnt(12)
    s_nop 0
    v_mfma_f32_16x16x32_bf16 v[16:19], v[204:207], v[12:15], v[16:19]
    v_perm_b32 v1, v46, v46, s40
    v_and_b32 v8, v1, v4
    v_and_b32 v9, v1, v5
    v_and_b32 v10, v1, v6
    v_and_b32 v11, v1, v7
    s_waitcnt vmcnt(11)
    s_nop 0
    v_mfma_f32_16x16x32_bf16 v[16:19], v[208:211], v[8:11], v[16:19]
    v_perm_b32 v1, v46, v46, s41
    v_and_b32 v12, v1, v4
    v_and_b32 v13, v1, v5
    v_and_b32 v14, v1, v6
    v_and_b32 v15, v1, v7
    s_waitcnt vmcnt(10)
    s_nop 0
    v_mfma_f32_16x16x32_bf16 v[16:19], v[212:215], v[12:15], v[16:19]
    v_perm_b32 v1, v47, v47, s40
    v_and_b32 v8, v1, v4
    v_and_b32 v9, v1, v5
    v_and_b32 v10, v1, v6
    v_and_b32 v11, v1, v7
    s_waitcnt vmcnt(9)
    s_nop 0
    v_mfma_f32_16x16x32_bf16 v[16:19], v[216:219], v[8:11], v[16:19]
    v_perm_b32 v1, v47, v47, s41
    v_and_b32 v12, v1, v4
    v_and_b32 v13, v1, v5
    v_and_b32 v14, v1, v6
    v_and_b32 v15, v1, v7
    s_waitcnt vmcnt(8)
    s_nop 0
    v_mfma_f32_16x16x32_bf16 v[16:19], v[220:223], v[12:15], v[16:19]
    v_perm_b32 v1, v48, v48, s40
    v_and_b32 v8, v1, v4
    v_and_b32 v9, v1, v5
    v_and_b32 v10, v1, v6
    v_and_b32 v11, v1, v7
    s_waitcnt vmcnt(7)
    s_nop 0
    v_mfma_f32_16x16x32_bf16 v[16:19], v[224:227], v[8:11], v[16:19]
    v_perm_b32 v1, v48, v48, s41
    v_and_b32 v12, v1, v4
    v_and_b32 v13, v1, v5
    v_and_b32 v14, v1, v6
    v_and_b32 v15, v1, v7
    s_waitcnt vmcnt(6)
    s_nop 0
    v_mfma_f32_16x16x32_bf16 v[16:19], v[228:231], v[12:15], v[16:19]
    v_perm_b32 v1, v49, v49, s40
    v_and_b32 v8, v1, v4
    v_and_b32 v9, v1, v5
    v_and_b32 v10, v1, v6
    v_and_b32 v11, v1, v7
    s_waitcnt vmcnt(5)
    s_nop 0
    v_mfma_f32_16x16x32_bf16 v[16:19], v[232:235], v[8:11], v[16:19]
    v_perm_b32 v1, v49, v49, s41
    v_and_b32 v12, v1, v4
    v_and_b32 v13, v1, v5
    v_and_b32 v14, v1, v6
    v_and_b32 v15, v1, v7
    s_waitcnt vmcnt(4)
    s_nop 0
    v_mfma_f32_16x16x32_bf16 v[16:19], v[236:239], v[12:15], v[16:19]
    v_perm_b32 v1, v50, v50, s40
    v_and_b32 v8, v1, v4
    v_and_b32 v9, v1, v5
    v_and_b32 v10, v1, v6
    v_and_b32 v11, v1, v7
    s_waitcnt vmcnt(3)
    s_nop 0
    v_mfma_f32_16x16x32_bf16 v[16:19], v[240:243], v[8:11], v[16:19]
    v_perm_b32 v1, v50, v50, s41
    v_and_b32 v12, v1, v4
    v_and_b32 v13, v1, v5
    v_and_b32 v14, v1, v6
    v_and_b32 v15, v1, v7
    s_waitcnt vmcnt(2)
    s_nop 0
    v_mfma_f32_16x16x32_bf16 v[16:19], v[244:247], v[12:15], v[16:19]
    v_perm_b32 v1, v51, v51, s40
    v_and_b32 v8, v1, v4
    v_and_b32 v9, v1, v5
    v_and_b32 v10, v1, v6
    v_and_b32 v11, v1, v7
    s_waitcnt vmcnt(1)
    s_nop 0
    v_mfma_f32_16x16x32_bf16 v[16:19], v[248:251], v[8:11], v[16:19]
    v_perm_b32 v1, v51, v51, s41
    v_and_b32 v12, v1, v4
    v_and_b32 v13, v1, v5
    v_and_b32 v14, v1, v6
    v_and_b32 v15, v1, v7
    s_waitcnt vmcnt(0)
    s_nop 0
    v_mfma_f32_16x16x32_bf16 v[16:19], v[252:255], v[12:15], v[16:19]
    s_nop 7
    v_and_or_b32 v16, v16, v22, s94
    v_and_or_b32 v17, v17, v22, s95
    v_and_or_b32 v18, v18, v22, s96
    v_and_or_b32 v19, v19, v22, s97
    buffer_store_dwordx4 v[16:19], v21, s[44:47], 0 offen sc1
L_st2:
    s_mov_b32 s36, s24
    s_mov_b32 s37, s25
    s_mov_b32 s38, 5308416
    s_mov_b32 s39, 0x20000
    s_mul_i32 s43, s82, 0x3334
    s_lshr_b32 s43, s43, 16
    s_mul_i32 s40, s43, 5
    s_sub_u32 s83, s82, s40
    s_mul_i32 s40, s43, 110592
    s_lshl_b32 s41, s83, 8
    s_add_u32 s40, s40, s41
    v_and_b32 v1, 15, v0
    v_lshlrev_b32 v1, 4, v1
    v_mul_u32_u24 v20, 27648, v25
    v_add3_u32 v20, v20, v1, s40
    s_cmp_eq_u32 s83, 4
    s_cselect_b32 s40, 0x40000000, 0
    s_cselect_b32 s85, 0, -1
    s_mov_b32 s84, -1
    v_mul_lo_u32 v2, s40, v27
    v_add_u32 v20, v20, v2
    s_lshl_b32 s40, s83, 16
    s_lshl_b32 s41, s43, 6
    s_add_u32 s40, s40, s41
    s_add_u32 s40, s40, 1441792
    v_mul_u32_u24 v21, 294912, v27
    v_lshl_add_u32 v21, v25, 14, v21
    v_bfe_u32 v2, v0, 2, 1
    v_lshl_add_u32 v21, v2, 13, v21
    v_and_b32 v2, 3, v0
    v_lshl_add_u32 v21, v2, 4, v21
    v_add_u32 v21, s40, v21
    v_cmp_le_u32 vcc, 24, v0
    s_mul_i32 s40, s43, 384
    s_add_u32 s40, s40, 2097152
    v_cndmask_b32 v2, 0, 1, vcc
    v_mul_u32_u24 v3, 24, v2
    v_sub_u32 v3, v0, v3
    v_mul_u32_u24 v23, 18432, v2
    v_lshl_add_u32 v23, v3, 4, v23
    v_add_u32 v23, s40, v23
    v_lshrrev_b32 v60, 3, v3
    v_and_b32 v3, 7, v3
    v_lshl_add_u32 v60, v60, 5, v3
    v_lshlrev_b32 v60, 1, v60
    v_mul_u32_u24 v2, 192, v2
    v_add_u32 v60, v60, v2
    v_mul_u32_u24 v24, 48, v25
    v_mul_u32_u24 v2, 192, v27
    v_add_u32 v24, v24, v2
    s_mov_b32 s57, 4000000
L_wpg:
    s_sleep 16
    v_mov_b32 v2, 0
    ds_read_b32 v2, v2 offset:512
    s_waitcnt lgkmcnt(0)
    v_readfirstlane_b32 s58, v2
    s_cmp_lt_u32 s58, 64
    s_cbranch_scc1 L_wpg
    s_mov_b32 exec_hi, 0xffff
L_gpoll:
    s_mov_b32 s40, 0
    buffer_load_dwordx4 v[28:31], v23, s[44:47], s40 offen sc1
    s_mov_b32 s40, 36864
    buffer_load_dwordx4 v[32:35], v23, s[44:47], s40 offen sc1
    s_mov_b32 s40, 73728
    buffer_load_dwordx4 v[36:39], v23, s[44:47], s40 offen sc1
    s_mov_b32 s40, 110592
    buffer_load_dwordx4 v[40:43], v23, s[44:47], s40 offen sc1
    s_mov_b32 s40, 147456
    buffer_load_dwordx4 v[44:47], v23, s[44:47], s40 offen sc1
    s_mov_b32 s40, 184320
    buffer_load_dwordx4 v[48:51], v23, s[44:47], s40 offen sc1
    s_waitcnt vmcnt(0)
    v_xor_b32 v28, s94, v28
    v_xor_b32 v29, s95, v29
    v_xor_b32 v30, s96, v30
    v_xor_b32 v31, s97, v31
    v_xor_b32 v32, s94, v32
    v_xor_b32 v33, s95, v33
    v_xor_b32 v34, s96, v34
    v_xor_b32 v35, s97, v35
    v_xor_b32 v36, s94, v36
    v_xor_b32 v37, s95, v37
    v_xor_b32 v38, s96, v38
    v_xor_b32 v39, s97, v39
    v_xor_b32 v40, s94, v40
    v_xor_b32 v41, s95, v41
    v_xor_b32 v42, s96, v42
    v_xor_b32 v43, s97, v43
    v_xor_b32 v44, s94, v44
    v_xor_b32 v45, s95, v45
    v_xor_b32 v46, s96, v46
    v_xor_b32 v47, s97, v47
    v_xor_b32 v48, s94, v48
    v_xor_b32 v49, s95, v49
    v_xor_b32 v50, s96, v50
    v_xor_b32 v51, s97, v51
    v_or_b32 v2, v28, v29
    v_or3_b32 v2, v2, v30, v31
    v_or3_b32 v2, v2, v32, v33
    v_or3_b32 v2, v2, v34, v35
    v_or3_b32 v2, v2, v36, v37
    v_or3_b32 v2, v2, v38, v39
    v_or3_b32 v2, v2, v40, v41
    v_or3_b32 v2, v2, v42, v43
    v_or3_b32 v2, v2, v44, v45
    v_or3_b32 v2, v2, v46, v47
    v_or3_b32 v2, v2, v48, v49
    v_or3_b32 v2, v2, v50, v51
    v_and_b32 v2, 0xff, v2
    v_cmp_ne_u32 vcc, 0, v2
    s_cbranch_vccz L_gready
    s_sleep 48
    s_sub_u32 s57, s57, 1
    s_cmp_lg_u32 s57, 0
    s_cbranch_scc1 L_gpoll
L_gready:
    v_add_f32 v28, v28, v32
    v_add_f32 v40, v40, v44
    v_add_f32 v28, v28, v36
    v_add_f32 v40, v40, v48
    v_cvt_pk_bf16_f32 v28, v28, v28
    v_and_b32 v28, 0xffff0000, v28
    v_cvt_pk_bf16_f32 v40, v40, v40
    v_and_b32 v40, 0xffff0000, v40
    v_mul_f32 v2, 0xbfb8aa3b, v28
    v_exp_f32 v2, v2
    s_nop 0
    v_add_f32 v2, 1.0, v2
    v_rcp_f32 v2, v2
    s_nop 0
    v_mul_f32 v28, v28, v2
    v_cvt_pk_bf16_f32 v28, v28, v28
    v_and_b32 v28, 0xffff0000, v28
    v_mul_f32 v28, v28, v40
    v_cvt_pk_bf16_f32 v28, v28, v28
    ds_write_b16 v60, v28 offset:4096
    v_add_f32 v29, v29, v33
    v_add_f32 v41, v41, v45
    v_add_f32 v29, v29, v37
    v_add_f32 v41, v41, v49
    v_cvt_pk_bf16_f32 v29, v29, v29
    v_and_b32 v29, 0xffff0000, v29
    v_cvt_pk_bf16_f32 v41, v41, v41
    v_and_b32 v41, 0xffff0000, v41
    v_mul_f32 v2, 0xbfb8aa3b, v29
    v_exp_f32 v2, v2
    s_nop 0
    v_add_f32 v2, 1.0, v2
    v_rcp_f32 v2, v2
    s_nop 0
    v_mul_f32 v29, v29, v2
    v_cvt_pk_bf16_f32 v29, v29, v29
    v_and_b32 v29, 0xffff0000, v29
    v_mul_f32 v29, v29, v41
    v_cvt_pk_bf16_f32 v29, v29, v29
    ds_write_b16 v60, v29 offset:4112
    v_add_f32 v30, v30, v34
    v_add_f32 v42, v42, v46
    v_add_f32 v30, v30, v38
    v_add_f32 v42, v42, v50
    v_cvt_pk_bf16_f32 v30, v30, v30
    v_and_b32 v30, 0xffff0000, v30
    v_cvt_pk_bf16_f32 v42, v42, v42
    v_and_b32 v42, 0xffff0000, v42
    v_mul_f32 v2, 0xbfb8aa3b, v30
    v_exp_f32 v2, v2
    s_nop 0
    v_add_f32 v2, 1.0, v2
    v_rcp_f32 v2, v2
    s_nop 0
    v_mul_f32 v30, v30, v2
    v_cvt_pk_bf16_f32 v30, v30, v30
    v_and_b32 v30, 0xffff0000, v30
    v_mul_f32 v30, v30, v42
    v_cvt_pk_bf16_f32 v30, v30, v30
    ds_write_b16 v60, v30 offset:4128
    v_add_f32 v31, v31, v35
    v_add_f32 v43, v43, v47
    v_add_f32 v31, v31, v39
    v_add_f32 v43, v43, v51
    v_cvt_pk_bf16_f32 v31, v31, v31
    v_and_b32 v31, 0xffff0000, v31
    v_cvt_pk_bf16_f32 v43, v43, v43
    v_and_b32 v43, 0xffff0000, v43
    v_mul_f32 v2, 0xbfb8aa3b, v31
    v_exp_f32 v2, v2
    s_nop 0
    v_add_f32 v2, 1.0, v2
    v_rcp_f32 v2, v2
    s_nop 0
    v_mul_f32 v31, v31, v2
    v_cvt_pk_bf16_f32 v31, v31, v31
    v_and_b32 v31, 0xffff0000, v31
    v_mul_f32 v31, v31, v43
    v_cvt_pk_bf16_f32 v31, v31, v31
    ds_write_b16 v60, v31 offset:4144
    s_mov_b64 exec, -1
    s_waitcnt lgkmcnt(0)
    ds_read_b128 v[28:31], v24 offset:4096
    ds_read_b128 v[32:35], v24 offset:4112
    ds_read_b128 v[36:39], v24 offset:4128
    s_mov_b32 s40, 0x01000100
    s_mov_b32 s41, 0x03020302
    s_waitcnt lgkmcnt(0)
    v_perm_b32 v1, v28, v28, s40
    v_and_b32 v64, v1, v4
    v_and_b32 v65, v1, v5
    v_and_b32 v66, v1, v6
    v_and_b32 v67, v1, v7
    v_perm_b32 v1, v28, v28, s41
    v_and_b32 v68, v1, v4
    v_and_b32 v69, v1, v5
    v_and_b32 v70, v1, v6
    v_and_b32 v71, v1, v7
    v_perm_b32 v1, v29, v29, s40
    v_and_b32 v72, v1, v4
    v_and_b32 v73, v1, v5
    v_and_b32 v74, v1, v6
    v_and_b32 v75, v1, v7
    v_perm_b32 v1, v29, v29, s41
    v_and_b32 v76, v1, v4
    v_and_b32 v77, v1, v5
    v_and_b32 v78, v1, v6
    v_and_b32 v79, v1, v7
    v_perm_b32 v1, v30, v30, s40
    v_and_b32 v80, v1, v4
    v_and_b32 v81, v1, v5
    v_and_b32 v82, v1, v6
    v_and_b32 v83, v1, v7
    v_perm_b32 v1, v30, v30, s41
    v_and_b32 v84, v1, v4
    v_and_b32 v85, v1, v5
    v_and_b32 v86, v1, v6
    v_and_b32 v87, v1, v7
    v_perm_b32 v1, v31, v31, s40
    v_and_b32 v88, v1, v4
    v_and_b32 v89, v1, v5
    v_and_b32 v90, v1, v6
    v_and_b32 v91, v1, v7
    v_perm_b32 v1, v31, v31, s41
    v_and_b32 v92, v1, v4
    v_and_b32 v93, v1, v5
    v_and_b32 v94, v1, v6
    v_and_b32 v95, v1, v7
    v_perm_b32 v1, v32, v32, s40
    v_and_b32 v96, v1, v4
    v_and_b32 v97, v1, v5
    v_and_b32 v98, v1, v6
    v_and_b32 v99, v1, v7
    v_perm_b32 v1, v32, v32, s41
    v_and_b32 v100, v1, v4
    v_and_b32 v101, v1, v5
    v_and_b32 v102, v1, v6
    v_and_b32 v103, v1, v7
    v_perm_b32 v1, v33, v33, s40
    v_and_b32 v104, v1, v4
    v_and_b32 v105, v1, v5
    v_and_b32 v106, v1, v6
    v_and_b32 v107, v1, v7
    v_perm_b32 v1, v33, v33, s41
    v_and_b32 v108, v1, v4
    v_and_b32 v109, v1, v5
    v_and_b32 v110, v1, v6
    v_and_b32 v111, v1, v7
    v_perm_b32 v1, v34, v34, s40
    v_and_b32 v112, v1, v4
    v_and_b32 v113, v1, v5
    v_and_b32 v114, v1, v6
    v_and_b32 v115, v1, v7
    v_perm_b32 v1, v34, v34, s41
    v_and_b32 v116, v1, v4
    v_and_b32 v117, v1, v5
    v_and_b32 v118, v1, v6
    v_and_b32 v119, v1, v7
    v_perm_b32 v1, v35, v35, s40
    v_and_b32 v120, v1, v4
    v_and_b32 v121, v1, v5
    v_and_b32 v122, v1, v6
    v_and_b32 v123, v1, v7
    v_perm_b32 v1, v35, v35, s41
    v_and_b32 v124, v1, v4
    v_and_b32 v125, v1, v5
    v_and_b32 v126, v1, v6
    v_and_b32 v127, v1, v7
    v_perm_b32 v1, v36, v36, s40
    v_and_b32 v128, v1, v4
    v_and_b32 v129, v1, v5
    v_and_b32 v130, v1, v6
    v_and_b32 v131, v1, v7
    v_perm_b32 v1, v36, v36, s41
    v_and_b32 v132, v1, v4
    v_and_b32 v133, v1, v5
    v_and_b32 v134, v1, v6
    v_and_b32 v135, v1, v7
    v_perm_b32 v1, v37, v37, s40
    v_and_b32 v136, v1, v4
    v_and_b32 v137, v1, v5
    v_and_b32 v138, v1, v6
    v_and_b32 v139, v1, v7
    v_perm_b32 v1, v37, v37, s41
    v_and_b32 v140, v1, v4
    v_and_b32 v141, v1, v5
    v_and_b32 v142, v1, v6
    v_and_b32 v143, v1, v7
    v_perm_b32 v1, v38, v38, s40
    v_and_b32 v144, v1, v4
    v_and_b32 v145, v1, v5
    v_and_b32 v146, v1, v6
    v_and_b32 v147, v1, v7
    v_perm_b32 v1, v38, v38, s41
    v_and_b32 v148, v1, v4
    v_and_b32 v149, v1, v5
    v_and_b32 v150, v1, v6
    v_and_b32 v151, v1, v7
    v_perm_b32 v1, v39, v39, s40
    v_and_b32 v152, v1, v4
    v_and_b32 v153, v1, v5
    v_and_b32 v154, v1, v6
    v_and_b32 v155, v1, v7
    v_perm_b32 v1, v39, v39, s41
    v_and_b32 v156, v1, v4
    v_and_b32 v157, v1, v5
    v_and_b32 v158, v1, v6
    v_and_b32 v159, v1, v7
    s_mov_b32 s48, 3456
    s_mov_b32 s49, 6912
    s_mov_b32 s50, 10368
    s_mov_b32 s51, 13824
    s_mov_b32 s52, 17280
    s_mov_b32 s53, 20736
    s_mov_b32 s54, 24192
    s_mov_b32 s32, s8
    s_mov_b32 s33, s9
    s_mov_b32 s34, 2304
    s_mov_b32 s35, 0x20000
    s_mov_b32 s88, s26
    s_mov_b32 s89, s27
    s_mov_b32 s90, 2304
    s_mov_b32 s91, 0x20000
    s_and_b32 s40, s5, 3
    s_lshl_b32 s41, s4, 2
    s_add_u32 s40, s40, s41
    s_lshl_b32 s40, s40, 1
    s_lshr_b32 s41, s5, 2
    s_xor_b32 s41, s41, 0
    s_add_u32 s82, s40, s41
    s_cmp_ge_u32 s82, 36
    s_cselect_b32 s42, 1, 0
    s_mul_i32 s40, s42, 36
    s_sub_u32 s56, s82, s40
    v_lshlrev_b32 v28, 4, v0
    s_mul_i32 s40, s42, 576
    s_lshr_b32 s41, s56, 1
    s_lshl_b32 s41, s41, 5
    s_add_u32 s40, s40, s41
    s_and_b32 s41, s56, 1
    s_lshl_b32 s41, s41, 2
    s_add_u32 s40, s40, s41
    v_and_b32 v29, 3, v0
    v_lshl_add_u32 v30, v25, 3, v29
    v_add_lshl_u32 v30, v30, s40, 1
    buffer_load_ushort v33, v30, s[32:35], 0 offen
    s_lshl_b32 s40, s82, 13
    s_add_u32 s55, s40, 1441792
    s_add_u32 s40, s40, 851968
    s_add_u32 s41, s40, 4096
    s_mov_b32 s56, 0x000f000f
    s_mov_b32 s57, 0x000f000f
    s_mov_b32 s43, 786432
    s_waitcnt vmcnt(0)
    v_lshlrev_b32 v33, 16, v33
    s_mov_b32 s46, 0
    s_mov_b32 s90, 0
    s_mov_b32 s38, 0
    s_mov_b32 s59, 1
    s_branch L_fdry
L_freal:
    s_mov_b32 s46, 4194304
    s_mov_b32 s90, 2304
    s_mov_b32 s38, 5308416
    s_mov_b32 s59, 4000000
    s_mov_b64 exec, -1
    s_waitcnt vmcnt(0)
    s_setprio 2
L_wpe:
    s_sleep 16
    v_mov_b32 v2, 0
    ds_read_b32 v2, v2 offset:512
    s_waitcnt lgkmcnt(0)
    v_readfirstlane_b32 s58, v2
    s_cmp_lt_u32 s58, 236
    s_cbranch_scc1 L_wpe
L_wde:
    s_sleep 2
    v_mov_b32 v2, 0
    ds_read2_b32 v[2:3], v2 offset0:128 offset1:131
    s_waitcnt lgkmcnt(0)
    v_readfirstlane_b32 s42, v2
    v_readfirstlane_b32 s58, v3
    s_cmp_lt_u32 s42, s58
    s_cbranch_scc1 L_wde
L_fdry:
    buffer_load_dwordx4 v[160:163], v20, s[36:39], 0 offen offset:0 nt
    buffer_load_dwordx4 v[164:167], v20, s[36:39], 0 offen offset:1152 nt
    buffer_load_dwordx4 v[168:171], v20, s[36:39], 0 offen offset:2304 nt
    buffer_load_dwordx4 v[172:175], v20, s[36:39], s48 offen offset:0 nt
    buffer_load_dwordx4 v[176:179], v20, s[36:39], s48 offen offset:1152 nt
    buffer_load_dwordx4 v[180:183], v20, s[36:39], s48 offen offset:2304 nt
    buffer_load_dwordx4 v[184:187], v20, s[36:39], s49 offen offset:0 nt
    buffer_load_dwordx4 v[188:191], v20, s[36:39], s49 offen offset:1152 nt
    buffer_load_dwordx4 v[192:195], v20, s[36:39], s49 offen offset:2304 nt
    buffer_load_dwordx4 v[196:199], v20, s[36:39], s50 offen offset:0 nt
    buffer_load_dwordx4 v[200:203], v20, s[36:39], s50 offen offset:1152 nt
    buffer_load_dwordx4 v[204:207], v20, s[36:39], s50 offen offset:2304 nt
    buffer_load_dwordx4 v[208:211], v20, s[36:39], s51 offen offset:0 nt
    buffer_load_dwordx4 v[212:215], v20, s[36:39], s51 offen offset:1152 nt
    buffer_load_dwordx4 v[216:219], v20, s[36:39], s51 offen offset:2304 nt
    buffer_load_dwordx4 v[220:223], v20, s[36:39], s52 offen offset:0 nt
    buffer_load_dwordx4 v[224:227], v20, s[36:39], s52 offen offset:1152 nt
    buffer_load_dwordx4 v[228:231], v20, s[36:39], s52 offen offset:2304 nt
    buffer_load_dwordx4 v[232:235], v20, s[36:39], s53 offen offset:0 nt
    buffer_load_dwordx4 v[236:239], v20, s[36:39], s53 offen offset:1152 nt
    buffer_load_dwordx4 v[240:243], v20, s[36:39], s53 offen offset:2304 nt
    buffer_load_dwordx4 v[244:247], v20, s[36:39], s54 offen offset:0 nt
    buffer_load_dwordx4 v[248:251], v20, s[36:39], s54 offen offset:1152 nt
    buffer_load_dwordx4 v[252:255], v20, s[36:39], s54 offen offset:2304 nt
    s_cmp_eq_u32 s59, 1
    s_cbranch_scc1 L_ftail
    s_barrier
    v_mov_b32 v2, 0
    ds_read_b32 v2, v2 offset:520
    s_waitcnt lgkmcnt(0)
    v_readfirstlane_b32 s42, v2
    v_xor_b32 v21, v21, v2
    s_xor_b32 s40, s40, s42
    s_xor_b32 s41, s41, s42
    s_xor_b32 s55, s55, s42
L_ftail:
    s_waitcnt vmcnt(23)
    v_mfma_f32_16x16x32_bf16 v[16:19], v[160:163], v[64:67], 0
    s_waitcnt vmcnt(22)
    v_mfma_f32_16x16x32_bf16 v[16:19], v[164:167], v[68:71], v[16:19]
    s_waitcnt vmcnt(21)
    v_mfma_f32_16x16x32_bf16 v[16:19], v[168:171], v[72:75], v[16:19]
    s_waitcnt vmcnt(20)
    v_mfma_f32_16x16x32_bf16 v[16:19], v[172:175], v[76:79], v[16:19]
    s_waitcnt vmcnt(19)
    v_mfma_f32_16x16x32_bf16 v[16:19], v[176:179], v[80:83], v[16:19]
    s_waitcnt vmcnt(18)
    v_mfma_f32_16x16x32_bf16 v[16:19], v[180:183], v[84:87], v[16:19]
    s_waitcnt vmcnt(17)
    v_mfma_f32_16x16x32_bf16 v[16:19], v[184:187], v[88:91], v[16:19]
    s_waitcnt vmcnt(16)
    v_mfma_f32_16x16x32_bf16 v[16:19], v[188:191], v[92:95], v[16:19]
    s_waitcnt vmcnt(15)
    v_mfma_f32_16x16x32_bf16 v[16:19], v[192:195], v[96:99], v[16:19]
    s_waitcnt vmcnt(14)
    v_mfma_f32_16x16x32_bf16 v[16:19], v[196:199], v[100:103], v[16:19]
    s_waitcnt vmcnt(13)
    v_mfma_f32_16x16x32_bf16 v[16:19], v[200:203], v[104:107], v[16:19]
    s_waitcnt vmcnt(12)
    v_mfma_f32_16x16x32_bf16 v[16:19], v[204:207], v[108:111], v[16:19]
    s_waitcnt vmcnt(11)
    v_mfma_f32_16x16x32_bf16 v[16:19], v[208:211], v[112:115], v[16:19]
    s_waitcnt vmcnt(10)
    v_mfma_f32_16x16x32_bf16 v[16:19], v[212:215], v[116:119], v[16:19]
    s_waitcnt vmcnt(9)
    v_mfma_f32_16x16x32_bf16 v[16:19], v[216:219], v[120:123], v[16:19]
    s_waitcnt vmcnt(8)
    v_mfma_f32_16x16x32_bf16 v[16:19], v[220:223], v[124:127], v[16:19]
    s_waitcnt vmcnt(7)
    v_mfma_f32_16x16x32_bf16 v[16:19], v[224:227], v[128:131], v[16:19]
    s_waitcnt vmcnt(6)
    v_mfma_f32_16x16x32_bf16 v[16:19], v[228:231], v[132:135], v[16:19]
    s_waitcnt vmcnt(5)
    v_mfma_f32_16x16x32_bf16 v[16:19], v[232:235], v[136:139], v[16:19]
    s_waitcnt vmcnt(4)
    v_mfma_f32_16x16x32_bf16 v[16:19], v[236:239], v[140:143], v[16:19]
    s_waitcnt vmcnt(3)
    v_mfma_f32_16x16x32_bf16 v[16:19], v[240:243], v[144:147], v[16:19]
    s_waitcnt vmcnt(2)
    v_mfma_f32_16x16x32_bf16 v[16:19], v[244:247], v[148:151], v[16:19]
    s_waitcnt vmcnt(1)
    v_mfma_f32_16x16x32_bf16 v[16:19], v[248:251], v[152:155], v[16:19]
    s_waitcnt vmcnt(0)
    v_mfma_f32_16x16x32_bf16 v[16:19], v[252:255], v[156:159], v[16:19]
    s_mov_b32 s42, s59
    s_nop 5
    s_mov_b64 exec, s[84:85]
    v_and_or_b32 v16, v16, v22, s94
    v_and_or_b32 v17, v17, v22, s95
    v_and_or_b32 v18, v18, v22, s96
    v_and_or_b32 v19, v19, v22, s97
    buffer_store_dwordx4 v[16:19], v21, s[44:47], 0 offen sc1
    s_mov_b64 exec, -1
    s_cmp_ge_u32 s4, 9
    s_cbranch_scc1 L_noepoch
L_ypoll:
    buffer_load_dwordx4 v[192:195], v28, s[44:47], s55 offen offset:0 sc1
    buffer_load_dwordx4 v[196:199], v28, s[44:47], s55 offen offset:1024 sc1
    buffer_load_dwordx4 v[200:203], v28, s[44:47], s55 offen offset:2048 sc1
    s_sub_u32 s42, s42, 1
    s_waitcnt vmcnt(0)
    v_xor_b32 v192, s94, v192
    v_xor_b32 v193, s95, v193
    v_xor_b32 v194, s96, v194
    v_xor_b32 v195, s97, v195
    v_xor_b32 v196, s94, v196
    v_xor_b32 v197, s95, v197
    v_xor_b32 v198, s96, v198
    v_xor_b32 v199, s97, v199
    v_xor_b32 v200, s94, v200
    v_xor_b32 v201, s95, v201
    v_xor_b32 v202, s96, v202
    v_xor_b32 v203, s97, v203
    v_or_b32 v2, v192, v193
    v_or3_b32 v2, v2, v194, v195
    v_or3_b32 v2, v2, v196, v197
    v_or3_b32 v2, v2, v198, v199
    v_or3_b32 v2, v2, v200, v201
    v_or3_b32 v2, v2, v202, v203
    v_and_b32 v2, 0xff, v2
    v_cmp_ne_u32 vcc, 0, v2
    s_cbranch_vccz L_yready
    s_cmp_lg_u32 s42, 0
    s_cbranch_scc1 L_ypoll
L_yready:
    buffer_load_dwordx4 v[160:163], v28, s[44:47], s40 offen offset:0 sc1
    buffer_load_dwordx4 v[164:167], v28, s[44:47], s40 offen offset:1024 sc1
    buffer_load_dwordx4 v[168:171], v28, s[44:47], s40 offen offset:2048 sc1
    buffer_load_dwordx4 v[172:175], v28, s[44:47], s40 offen offset:3072 sc1
    buffer_load_dwordx4 v[176:179], v28, s[44:47], s41 offen offset:0 sc1
    buffer_load_dwordx4 v[180:183], v28, s[44:47], s41 offen offset:1024 sc1
    buffer_load_dwordx4 v[184:187], v28, s[44:47], s41 offen offset:2048 sc1
    buffer_load_dwordx4 v[188:191], v28, s[44:47], s41 offen offset:3072 sc1
    s_mov_b32 s42, s59
    v_add_f32 v40, v192, v196
    v_add_f32 v41, v193, v197
    v_add_f32 v42, v194, v198
    v_add_f32 v43, v195, v199
    v_add_f32 v40, v40, v200
    v_add_f32 v41, v41, v201
    v_add_f32 v42, v42, v202
    v_add_f32 v43, v43, v203
    v_add_f32_dpp v40, v40, v40 row_ror:4 row_mask:0xf bank_mask:0xf
    v_add_f32_dpp v41, v41, v41 row_ror:4 row_mask:0xf bank_mask:0xf
    v_add_f32_dpp v42, v42, v42 row_ror:4 row_mask:0xf bank_mask:0xf
    v_add_f32_dpp v43, v43, v43 row_ror:4 row_mask:0xf bank_mask:0xf
    v_add_f32_dpp v40, v40, v40 row_ror:8 row_mask:0xf bank_mask:0xf
    v_add_f32_dpp v41, v41, v41 row_ror:8 row_mask:0xf bank_mask:0xf
    v_add_f32_dpp v42, v42, v42 row_ror:8 row_mask:0xf bank_mask:0xf
    v_add_f32_dpp v43, v43, v43 row_ror:8 row_mask:0xf bank_mask:0xf
    s_nop 0
    v_permlane16_swap_b32 v40, v41
    v_permlane16_swap_b32 v42, v43
    v_add_f32 v40, v40, v41
    v_add_f32 v42, v42, v43
    s_nop 1
    v_permlane32_swap_b32 v40, v42
    s_nop 0
    v_add_f32 v40, v40, v42
    v_cvt_pk_bf16_f32 v40, v40, v40
    v_and_b32 v40, 0xffff0000, v40
    v_mul_f32 v2, 0xbfb8aa3b, v40
    v_exp_f32 v2, v2
    s_nop 0
    v_add_f32 v2, 1.0, v2
    v_rcp_f32 v2, v2
    s_nop 0
    v_mul_f32 v40, v40, v2
    v_cvt_pk_bf16_f32 v40, v40, v40
    v_and_b32 v40, 0xffff0000, v40
    s_branch L_scheck
L_spoll:
    buffer_load_dwordx4 v[160:163], v28, s[44:47], s40 offen offset:0 sc1
    buffer_load_dwordx4 v[164:167], v28, s[44:47], s40 offen offset:1024 sc1
    buffer_load_dwordx4 v[168:171], v28, s[44:47], s40 offen offset:2048 sc1
    buffer_load_dwordx4 v[172:175], v28, s[44:47], s40 offen offset:3072 sc1
    buffer_load_dwordx4 v[176:179], v28, s[44:47], s41 offen offset:0 sc1
    buffer_load_dwordx4 v[180:183], v28, s[44:47], s41 offen offset:1024 sc1
    buffer_load_dwordx4 v[184:187], v28, s[44:47], s41 offen offset:2048 sc1
    buffer_load_dwordx4 v[188:191], v28, s[44:47], s41 offen offset:3072 sc1
L_scheck:
    s_sub_u32 s42, s42, 1
    s_waitcnt vmcnt(7)
    v_xor_b32 v160, s94, v160
    v_xor_b32 v161, s95, v161
    v_xor_b32 v162, s96, v162
    v_xor_b32 v163, s97, v163
    v_or_b32 v2, v160, v161
    v_or3_b32 v2, v2, v162, v163
    s_waitcnt vmcnt(6)
    v_xor_b32 v164, s94, v164
    v_xor_b32 v165, s95, v165
    v_xor_b32 v166, s96, v166
    v_xor_b32 v167, s97, v167
    v_or3_b32 v2, v2, v164, v165
    v_or3_b32 v2, v2, v166, v167
    v_pk_add_f32 v[36:37], v[160:161], v[164:165]
    v_pk_add_f32 v[38:39], v[162:163], v[166:167]
    s_waitcnt vmcnt(5)
    v_xor_b32 v168, s94, v168
    v_xor_b32 v169, s95, v169
    v_xor_b32 v170, s96, v170
    v_xor_b32 v171, s97, v171
    v_or3_b32 v2, v2, v168, v169
    v_or3_b32 v2, v2, v170, v171
    v_pk_add_f32 v[36:37], v[36:37], v[168:169]
    v_pk_add_f32 v[38:39], v[38:39], v[170:171]
    s_waitcnt vmcnt(4)
    v_xor_b32 v172, s94, v172
    v_xor_b32 v173, s95, v173
    v_xor_b32 v174, s96, v174
    v_xor_b32 v175, s97, v175
    v_or3_b32 v2, v2, v172, v173
    v_or3_b32 v2, v2, v174, v175
    v_pk_add_f32 v[36:37], v[36:37], v[172:173]
    v_pk_add_f32 v[38:39], v[38:39], v[174:175]
    s_waitcnt vmcnt(3)
    v_xor_b32 v176, s94, v176
    v_xor_b32 v177, s95, v177
    v_xor_b32 v178, s96, v178
    v_xor_b32 v179, s97, v179
    v_or3_b32 v2, v2, v176, v177
    v_or3_b32 v2, v2, v178, v179
    v_pk_add_f32 v[36:37], v[36:37], v[176:177]
    v_pk_add_f32 v[38:39], v[38:39], v[178:179]
    s_waitcnt vmcnt(2)
    v_xor_b32 v180, s94, v180
    v_xor_b32 v181, s95, v181
    v_xor_b32 v182, s96, v182
    v_xor_b32 v183, s97, v183
    v_or3_b32 v2, v2, v180, v181
    v_or3_b32 v2, v2, v182, v183
    v_pk_add_f32 v[36:37], v[36:37], v[180:181]
    v_pk_add_f32 v[38:39], v[38:39], v[182:183]
    s_waitcnt vmcnt(1)
    v_xor_b32 v184, s94, v184
    v_xor_b32 v185, s95, v185
    v_xor_b32 v186, s96, v186
    v_xor_b32 v187, s97, v187
    v_or3_b32 v2, v2, v184, v185
    v_or3_b32 v2, v2, v186, v187
    v_pk_add_f32 v[36:37], v[36:37], v[184:185]
    v_pk_add_f32 v[38:39], v[38:39], v[186:187]
    s_waitcnt vmcnt(0)
    v_xor_b32 v188, s94, v188
    v_xor_b32 v189, s95, v189
    v_xor_b32 v190, s96, v190
    v_xor_b32 v191, s97, v191
    v_or3_b32 v2, v2, v188, v189
    v_or3_b32 v2, v2, v190, v191
    v_pk_add_f32 v[36:37], v[36:37], v[188:189]
    v_pk_add_f32 v[38:39], v[38:39], v[190:191]
    v_and_b32 v2, 0xff, v2
    v_cmp_ne_u32 vcc, 0, v2
    s_cbranch_vccz L_sready
    s_cmp_lg_u32 s42, 0
    s_cbranch_scc1 L_spoll
L_sready:
    v_add_f32_dpp v36, v36, v36 row_ror:4 row_mask:0xf bank_mask:0xf
    v_add_f32_dpp v37, v37, v37 row_ror:4 row_mask:0xf bank_mask:0xf
    v_add_f32_dpp v38, v38, v38 row_ror:4 row_mask:0xf bank_mask:0xf
    v_add_f32_dpp v39, v39, v39 row_ror:4 row_mask:0xf bank_mask:0xf
    v_add_f32_dpp v36, v36, v36 row_ror:8 row_mask:0xf bank_mask:0xf
    v_add_f32_dpp v37, v37, v37 row_ror:8 row_mask:0xf bank_mask:0xf
    v_add_f32_dpp v38, v38, v38 row_ror:8 row_mask:0xf bank_mask:0xf
    v_add_f32_dpp v39, v39, v39 row_ror:8 row_mask:0xf bank_mask:0xf
    s_nop 0
    v_permlane16_swap_b32 v36, v37
    v_permlane16_swap_b32 v38, v39
    v_add_f32 v36, v36, v37
    v_add_f32 v38, v38, v39
    s_nop 1
    v_permlane32_swap_b32 v36, v38
    s_nop 0
    v_add_f32 v36, v36, v38
    v_cvt_pk_bf16_f32 v36, v36, v36
    v_and_b32 v36, 0xffff0000, v36
    v_mul_f32 v36, v36, v40
    v_cvt_pk_bf16_f32 v36, v36, v36
    v_and_b32 v36, 0xffff0000, v36
    v_add_f32 v36, v36, v33
    v_cvt_pk_bf16_f32 v36, v36, v36
    s_mov_b64 exec, s[56:57]
    buffer_store_short v36, v30, s[88:91], 0 offen
    s_cmp_lg_u32 s82, 0
    s_cbranch_scc1 L_noepoch
    s_mov_b64 exec, 1
    v_mov_b32 v2, s93
    buffer_store_dword v2, off, s[44:47], s43
L_noepoch:
    s_cmp_eq_u32 s59, 1
    s_cbranch_scc1 L_freal
L_end:
    s_endpgm
.section .rodata,"a"
.p2align 6
.amdhsa_kernel recurrent_scan__gqa_block_cached__swiglu_ffn__decode_kernel
  .amdhsa_next_free_vgpr 256
  .amdhsa_next_free_sgpr 98
  .amdhsa_accum_offset 256
  .amdhsa_group_segment_fixed_size 0
  .amdhsa_kernarg_size 96
  .amdhsa_user_sgpr_count 2
  .amdhsa_user_sgpr_kernarg_segment_ptr 1
  .amdhsa_system_sgpr_workgroup_id_x 1
.end_amdhsa_kernel
```
